```python
import torch

def _softmax(x, axis=-1):
    return torch.softmax(x, dim=axis)
def _gelu(x):
    return torch.nn.functional.gelu(x, approximate="tanh")
def _silu(x):
    return torch.nn.functional.silu(x)
def _sigmoid(x):
    return torch.sigmoid(x)
def _layernorm(x, axis=-1, eps=1e-5):
    m = x.mean(dim=axis, keepdim=True)
    v = x.var(dim=axis, keepdim=True, unbiased=False)
    return (x - m) / torch.sqrt(v + eps)
def _scatter_add(tgt, idx, src, axis=0):
    return tgt.clone().index_add_(axis, idx, src)
def _segment_sum(src, seg, n):
    out = torch.zeros((n,) + src.shape[1:], dtype=src.dtype)
    return out.index_add_(0, seg, src)
def _pad(x, pw):
    flat = tuple(v for pair in reversed(pw) for v in pair)
    return torch.nn.functional.pad(x, flat)

kernel_name = 'interleave_layers__gqa_block_cached__glu_gated_reglu__decode'

def setup_inputs():

    _w = (lambda a: (lambda t: t.to(torch.bfloat16) if t.is_floating_point() else t)(torch.as_tensor(a)))
    def _A_setup():
        B, Sq, D = 1, 1, 576
        Hq, Hkv, Sk, Dh = 32, 16, 65536, 128
        assert Hq % Hkv == 0, (Hq, Hkv)
        return {
            "x": _w((lambda *s: torch.randn(*s, dtype=torch.bfloat16) * 0.05)(B, Sq, D)),
            "k_cache": _w((lambda *s: torch.randn(*s, dtype=torch.bfloat16) * 0.8)(B, Hkv, Sk, Dh)),
            "v_cache": _w((lambda *s: torch.randn(*s, dtype=torch.bfloat16) * 1.6)(B, Hkv, Sk, Dh)),
            "wq": _w((lambda *s: torch.randn(*s, dtype=torch.bfloat16) * 0.8)(D, Hq * Dh) * (D ** -0.5)),
            "wo": _w((lambda *s: torch.randn(*s, dtype=torch.bfloat16) * 1.6)(Hq * Dh, D) * ((Hq * Dh) ** -0.5)),
        }
    _A_in = _A_setup()

    def _B_setup():
        B, S, D, F = 1, 1, 576, 4608
        return {
            "x": _w((lambda *s: torch.randn(*s, dtype=torch.bfloat16) * 0.05)(B, S, D)),
            "W_gate": _w((lambda *s: torch.randn(*s, dtype=torch.bfloat16) * 0.4)(D, F) * (2.0 / D) ** 0.5),
            "W_up": _w((lambda *s: torch.randn(*s, dtype=torch.bfloat16) * 0.4)(D, F) * (2.0 / D) ** 0.5),
            "W_down": _w((lambda *s: torch.randn(*s, dtype=torch.bfloat16) * 0.4)(F, D) * (1.0 / F) ** 0.5),
        }
    _B_in = _B_setup()

    return {
        "A_x": _A_in["x"],
        "A_k_cache": _A_in["k_cache"],
        "A_v_cache": _A_in["v_cache"],
        "A_wq": _A_in["wq"],
        "A_wo": _A_in["wo"],
        "B_x": _B_in["x"],
        "B_W_gate": _B_in["W_gate"],
        "B_W_up": _B_in["W_up"],
        "B_W_down": _B_in["W_down"],
    }

def reference(A_x, A_k_cache, A_v_cache, A_wq, A_wo, B_x, B_W_gate, B_W_up, B_W_down):
    def _A_ref(x, k_cache, v_cache, wq, wo):
        B, Sq, D = x.shape
        Hq, Dh = 32, 128
        Hkv = k_cache.shape[1]
        rep = Hq // Hkv
        q = (lambda x, *d: x.permute(*d))((x @ wq).reshape(B, Sq, Hq, Dh), 0, 2, 1, 3)
        k = (lambda x, n, axis: torch.repeat_interleave(x, n, dim=axis))(k_cache, rep, axis=1)
        v = (lambda x, n, axis: torch.repeat_interleave(x, n, dim=axis))(v_cache, rep, axis=1)
        scores = torch.einsum("bhqd,bhkd->bhqk", q, k) * (Dh ** -0.5)
        p = _softmax(scores, axis=-1)
        o = torch.einsum("bhqk,bhkd->bhqd", p, v)
        return (lambda x, *d: x.permute(*d))(o, 0, 2, 1, 3).reshape(B, Sq, Hq * Dh) @ wo

    def _B_ref(x, W_gate, W_up, W_down):
        gate = torch.einsum("bsd,df->bsf", x, W_gate)
        up = torch.einsum("bsd,df->bsf", x, W_up)
        gate = gate * (lambda x, dt: x.to(dt))(gate > 0, gate.dtype)
        h = gate * up
        return torch.einsum("bsf,fd->bsd", h, W_down)

    x = A_x
    x = x + _A_ref(_layernorm(x, axis=-1), A_k_cache, A_v_cache, A_wq, A_wo)
    x = x + _B_ref(_layernorm(x, axis=-1), B_W_gate, B_W_up, B_W_down)
    x = x + _A_ref(_layernorm(x, axis=-1), A_k_cache, A_v_cache, A_wq, A_wo)
    x = x + _B_ref(_layernorm(x, axis=-1), B_W_gate, B_W_up, B_W_down)
    return x
```

```asm
; @launch grid=(256,1,1) block=(256,1,1) lds=163840
.amdgcn_target "amdgcn-amd-amdhsa--gfx950"
.text
.globl interleave_layers__gqa_block_cached__glu_gated_reglu__decode_kernel
.p2align 8
.type interleave_layers__gqa_block_cached__glu_gated_reglu__decode_kernel,@function
interleave_layers__gqa_block_cached__glu_gated_reglu__decode_kernel:
    s_cmp_ge_u32 s2, 256
    s_cbranch_scc1 L_done
    s_load_dwordx16 s[64:79], s[0:1], 0
    s_load_dwordx8 s[80:87], s[0:1], 64
    v_lshrrev_b32 v2, 6, v0
    v_and_b32 v1, 63, v0
    v_readfirstlane_b32 s3, v2
    s_and_b32 s48, s2, 7
    s_lshr_b32 s49, s2, 3
    s_mov_b32 s50, 0
    s_mov_b32 s51, 0x3fb8aa3b
    s_lshl_b32 s52, s48, 1
    s_add_u32 s94, s49, s52
    s_and_b32 s94, s94, 15
    s_lshr_b32 s95, s49, 4
    s_add_u32 s95, s95, s52
    s_lshl_b32 s96, s94, 4
    s_add_u32 s96, s96, s95
    s_mul_i32 s96, s96, 1152
    s_lshl_b32 s90, s95, 20
    s_lshl_b32 s53, s3, 12
    s_add_u32 s90, s90, s53
    v_bfe_u32 v12, v1, 2, 2
    v_lshlrev_b32 v12, 8, v12
    v_lshrrev_b32 v13, 4, v1
    v_lshl_add_u32 v12, v13, 6, v12
    v_and_b32 v13, 3, v1
    v_lshl_add_u32 v12, v13, 4, v12
    s_lshl_b32 s52, s94, 24
    v_add_u32 v2, s52, v12
    v_lshlrev_b32 v12, 4, v1
    v_add_u32 v3, s52, v12
    v_and_b32 v12, 2, v1
    v_lshlrev_b32 v12, 3, v12
    v_mov_b32 v13, 0xffff
    v_lshlrev_b32 v4, v12, v13
    v_mov_b32 v11, 0
    v_mov_b32 v14, 6352
    ds_write_b32 v14, v11
    s_waitcnt lgkmcnt(0)
    s_mov_b32 s4, s66
    s_and_b32 s5, s67, 0xffff
    s_mov_b32 s6, 268435456
    s_mov_b32 s7, 0x20000
    s_mov_b32 s8, s68
    s_and_b32 s9, s69, 0xffff
    s_mov_b32 s10, 268435456
    s_mov_b32 s11, 0x20000
    s_add_u32 s62, s90, 655360
    buffer_load_dwordx4 v[192:195], v2, s[4:7], s62 offen offset:0 nt
    buffer_load_dwordx4 v[196:199], v2, s[4:7], s62 offen offset:1024 nt
    buffer_load_dwordx4 v[200:203], v2, s[4:7], s62 offen offset:2048 nt
    buffer_load_dwordx4 v[204:207], v2, s[4:7], s62 offen offset:3072 nt
    buffer_load_dwordx4 v[208:211], v3, s[8:11], s62 offen offset:0
    buffer_load_dwordx4 v[212:215], v3, s[8:11], s62 offen offset:1024
    buffer_load_dwordx4 v[216:219], v3, s[8:11], s62 offen offset:2048
    buffer_load_dwordx4 v[220:223], v3, s[8:11], s62 offen offset:3072
    s_mov_b32 s40, s64
    s_and_b32 s41, s65, 0xffff
    s_mov_b32 s42, 1152
    s_mov_b32 s43, 0x20000
    s_mov_b32 s20, s70
    s_and_b32 s21, s71, 0xffff
    s_mov_b32 s22, 4718592
    s_mov_b32 s23, 0x20000
    s_mov_b32 s24, s72
    s_and_b32 s25, s73, 0xffff
    s_mov_b32 s26, 4718592
    s_mov_b32 s27, 0x20000
    s_mov_b32 s28, s76
    s_and_b32 s29, s77, 0xffff
    s_mov_b32 s30, 5308416
    s_mov_b32 s31, 0x20000
    s_mov_b32 s32, s78
    s_and_b32 s33, s79, 0xffff
    s_mov_b32 s34, 5308416
    s_mov_b32 s35, 0x20000
    s_mov_b32 s36, s80
    s_and_b32 s37, s81, 0xffff
    s_mov_b32 s38, 5308416
    s_mov_b32 s39, 0x20000
    s_mov_b32 s44, s82
    s_and_b32 s45, s83, 0xffff
    s_mov_b32 s46, 1152
    s_mov_b32 s47, 0x20000
    s_mov_b32 s16, s84
    s_and_b32 s17, s85, 0xffff
    s_mov_b32 s18, 256
    s_mov_b32 s19, 0x20000
    s_mov_b32 s12, s86
    s_and_b32 s13, s87, 0xffff
    s_mov_b32 s14, 8388608
    s_mov_b32 s15, 0x20000
    s_mov_b32 s98, s84
    s_mov_b32 s99, s85
    s_lshl_b32 s53, s94, 8
    s_add_u32 s53, s53, 458752
    s_add_u32 s82, s86, s53
    s_addc_u32 s83, s87, 0
    s_add_u32 s78, s49, 0
    s_and_b32 s78, s78, 31
    s_add_u32 s79, s49, 2
    s_and_b32 s79, s79, 31
    s_add_u32 s80, s49, 1
    s_and_b32 s80, s80, 31
    s_mov_b32 s70, 0x00010001
    s_mov_b32 s71, 0x00010001
    s_cmp_lt_u32 s3, 2
    s_cselect_b32 s70, s70, 1
    s_cselect_b32 s71, s71, 0
    s_lshl_b32 s92, s48, 10
    s_lshl_b32 s53, s49, 5
    s_add_u32 s92, s92, s53
    s_lshl_b32 s93, s94, 9
    s_barrier
    s_cmp_eq_u32 s3, 0
    s_cbranch_scc1 L_w0
    v_lshrrev_b32 v12, 2, v1
    v_and_b32 v13, 3, v1
    v_mul_u32_u24 v14, 72, v12
    v_lshl_add_u32 v14, v13, 5, v14
    v_lshlrev_b32 v17, 2, v13
    s_cmp_eq_u32 s3, 3
    s_cbranch_scc1 L_ws_1
    s_cmp_eq_u32 s3, 2
    s_cselect_b32 s84, s32, s28
    s_cselect_b32 s85, s33, s29
    s_cselect_b32 s54, 4, 0
    s_add_u32 s54, s54, 100832
    s_mov_b32 s86, 5308416
    s_mov_b32 s87, 0x20000
    s_mov_b32 s74, 147456
    s_mul_i32 s52, s48, 1152
    v_mul_u32_u24 v15, 9216, v12
    s_add_u32 s55, s54, 20736
    s_mul_i32 s53, s79, 36
    s_branch L_ws_2
L_ws_1:
    s_mov_b32 s84, s36
    s_mov_b32 s85, s37
    s_mov_b32 s86, 5308416
    s_mov_b32 s87, 0x20000
    s_mov_b32 s74, 18432
    s_mul_i32 s52, s48, 663552
    v_mul_u32_u24 v15, 1152, v12
    s_mov_b32 s54, 142304
    s_mov_b32 s55, 142308
    s_mul_i32 s53, s80, 36
L_ws_2:
    s_bfe_u32 s61, s53, 0x20002
    s_and_b32 s53, s53, 0xfffffff0
    v_add_u32 v18, 0, v17
    v_subrev_u32 v18, s61, v18
    v_cmp_gt_u32 s[64:65], 9, v18
    v_add_u32 v18, 1, v17
    v_subrev_u32 v18, s61, v18
    v_cmp_gt_u32 s[66:67], 9, v18
    v_add_u32 v18, 2, v17
    v_subrev_u32 v18, s61, v18
    v_cmp_gt_u32 s[68:69], 9, v18
    v_add_u32 v18, 3, v17
    v_subrev_u32 v18, s61, v18
    v_cmp_gt_u32 s[72:73], 9, v18
    s_add_u32 s52, s52, s53
    v_lshl_add_u32 v15, v13, 4, v15
    v_add_u32 v60, s52, v15
    s_lshl_b32 s53, s61, 3
    s_sub_u32 s54, s54, s53
    s_sub_u32 s55, s55, s53
    v_add_u32 v56, s54, v14
    v_add_u32 v57, s55, v14
    s_mul_i32 s53, s78, 36
    s_bfe_u32 s75, s53, 0x20002
    s_and_b32 s53, s53, 0xfffffff0
    v_mul_u32_u24 v16, 1152, v12
    v_lshl_add_u32 v16, v13, 4, v16
    s_mul_i32 s52, s48, 589824
    s_add_u32 s52, s52, s53
    v_add_u32 v61, s52, v16
    s_lshl_b32 s53, s75, 3
    s_sub_u32 s53, 82400, s53
    v_add_u32 v58, s53, v14
    s_add_u32 s62, s90, 638976
    s_mov_b64 exec, -1
    s_waitcnt vmcnt(5)
    buffer_load_dwordx4 v[224:227], v2, s[4:7], s62 offen offset:0 nt
    s_mov_b32 s63, 0
    s_mov_b32 exec_lo, 0x77777777
    s_mov_b32 exec_hi, 0x77777777
    s_waitcnt vmcnt(6)
    buffer_load_dwordx4 v[24:27], v60, s[84:87], s63 offen
    s_mov_b64 exec, -1
    s_waitcnt vmcnt(6)
    buffer_load_dwordx4 v[228:231], v2, s[4:7], s62 offen offset:1024 nt
    s_mov_b64 exec, -1
    s_waitcnt vmcnt(6)
    buffer_load_dwordx4 v[232:235], v2, s[4:7], s62 offen offset:2048 nt
    s_mov_b64 exec, -1
    s_waitcnt vmcnt(6)
    buffer_load_dwordx4 v[236:239], v2, s[4:7], s62 offen offset:3072 nt
    s_add_u32 s63, s63, s74
    s_mov_b32 exec_lo, 0x77777777
    s_mov_b32 exec_hi, 0x77777777
    s_waitcnt vmcnt(6)
    buffer_load_dwordx4 v[28:31], v60, s[84:87], s63 offen
    s_mov_b64 exec, -1
    s_waitcnt vmcnt(6)
    buffer_load_dwordx4 v[240:243], v3, s[8:11], s62 offen offset:0
    s_mov_b64 exec, -1
    s_waitcnt vmcnt(6)
    buffer_load_dwordx4 v[244:247], v3, s[8:11], s62 offen offset:1024
    s_add_u32 s63, s63, s74
    s_mov_b32 exec_lo, 0x77777777
    s_mov_b32 exec_hi, 0x77777777
    s_waitcnt vmcnt(6)
    buffer_load_dwordx4 v[32:35], v60, s[84:87], s63 offen
    s_mov_b64 exec, -1
    s_waitcnt vmcnt(6)
    buffer_load_dwordx4 v[248:251], v3, s[8:11], s62 offen offset:2048
    s_waitcnt vmcnt(8)
    s_mov_b64 exec, s[64:65]
    ds_write_b32 v56, v24 offset:0
    s_mov_b64 exec, s[66:67]
    ds_write_b32 v56, v25 offset:8
    s_mov_b64 exec, s[68:69]
    ds_write_b32 v56, v26 offset:16
    s_mov_b64 exec, s[72:73]
    ds_write_b32 v56, v27 offset:24
    s_mov_b64 exec, -1
    s_mov_b64 exec, -1
    s_waitcnt vmcnt(6)
    buffer_load_dwordx4 v[252:255], v3, s[8:11], s62 offen offset:3072
    s_lshl_b32 s54, s3, 1
    s_sub_u32 s54, s54, 1
    s_add_u32 s62, s90, 1015808
    s_lshl_b32 s55, s54, 13
    s_add_u32 m0, s55, 25056
    s_nop 0
    s_mov_b64 exec, -1
    s_waitcnt vmcnt(6)
    buffer_load_dwordx4 v2, s[4:7], s62 offen offset:0 nt lds
    s_add_u32 s63, s63, s74
    s_mov_b32 exec_lo, 0x77777777
    s_mov_b32 exec_hi, 0x77777777
    s_waitcnt vmcnt(6)
    buffer_load_dwordx4 v[36:39], v60, s[84:87], s63 offen
    s_mov_b64 exec, -1
    s_waitcnt vmcnt(6)
    buffer_load_dwordx4 v2, s[4:7], s62 offen offset:1024 nt lds
    s_waitcnt vmcnt(8)
    s_mov_b64 exec, s[64:65]
    ds_write_b32 v56, v28 offset:1152
    s_mov_b64 exec, s[66:67]
    ds_write_b32 v56, v29 offset:1160
    s_mov_b64 exec, s[68:69]
    ds_write_b32 v56, v30 offset:1168
    s_mov_b64 exec, s[72:73]
    ds_write_b32 v56, v31 offset:1176
    s_mov_b64 exec, -1
    s_mov_b64 exec, -1
    s_waitcnt vmcnt(6)
    buffer_load_dwordx4 v2, s[4:7], s62 offen offset:2048 nt lds
    s_add_u32 s63, s63, s74
    s_mov_b32 exec_lo, 0x77777777
    s_mov_b32 exec_hi, 0x77777777
    s_waitcnt vmcnt(6)
    buffer_load_dwordx4 v[40:43], v60, s[84:87], s63 offen
    s_mov_b64 exec, -1
    s_waitcnt vmcnt(6)
    buffer_load_dwordx4 v2, s[4:7], s62 offen offset:3072 nt lds
    s_waitcnt vmcnt(8)
    s_mov_b64 exec, s[64:65]
    ds_write_b32 v56, v32 offset:2304
    s_mov_b64 exec, s[66:67]
    ds_write_b32 v56, v33 offset:2312
    s_mov_b64 exec, s[68:69]
    ds_write_b32 v56, v34 offset:2320
    s_mov_b64 exec, s[72:73]
    ds_write_b32 v56, v35 offset:2328
    s_mov_b64 exec, -1
    s_add_u32 m0, m0, 4096
    s_nop 0
    s_mov_b64 exec, -1
    s_waitcnt vmcnt(6)
    buffer_load_dwordx4 v3, s[8:11], s62 offen offset:0 nt lds
    s_mov_b64 exec, -1
    s_waitcnt vmcnt(6)
    buffer_load_dwordx4 v3, s[8:11], s62 offen offset:1024 nt lds
    s_add_u32 s63, s63, s74
    s_mov_b32 exec_lo, 0x77777777
    s_mov_b32 exec_hi, 0x77777777
    s_waitcnt vmcnt(6)
    buffer_load_dwordx4 v[44:47], v60, s[84:87], s63 offen
    s_mov_b64 exec, -1
    s_waitcnt vmcnt(6)
    buffer_load_dwordx4 v3, s[8:11], s62 offen offset:2048 nt lds
    s_waitcnt vmcnt(8)
    s_mov_b64 exec, s[64:65]
    ds_write_b32 v56, v36 offset:3456
    s_mov_b64 exec, s[66:67]
    ds_write_b32 v56, v37 offset:3464
    s_mov_b64 exec, s[68:69]
    ds_write_b32 v56, v38 offset:3472
    s_mov_b64 exec, s[72:73]
    ds_write_b32 v56, v39 offset:3480
    s_mov_b64 exec, -1
    s_mov_b64 exec, -1
    s_waitcnt vmcnt(6)
    buffer_load_dwordx4 v3, s[8:11], s62 offen offset:3072 nt lds
    s_add_u32 s63, s63, s74
    s_mov_b32 exec_lo, 0x77777777
    s_mov_b32 exec_hi, 0x77777777
    s_waitcnt vmcnt(6)
    buffer_load_dwordx4 v[48:51], v60, s[84:87], s63 offen
    s_lshl_b32 s54, s3, 1
    s_add_u32 s62, s90, 1032192
    s_lshl_b32 s55, s54, 13
    s_add_u32 m0, s55, 25056
    s_nop 0
    s_mov_b64 exec, -1
    s_waitcnt vmcnt(6)
    buffer_load_dwordx4 v2, s[4:7], s62 offen offset:0 nt lds
    s_waitcnt vmcnt(8)
    s_mov_b64 exec, s[64:65]
    ds_write_b32 v56, v40 offset:4608
    s_mov_b64 exec, s[66:67]
    ds_write_b32 v56, v41 offset:4616
    s_mov_b64 exec, s[68:69]
    ds_write_b32 v56, v42 offset:4624
    s_mov_b64 exec, s[72:73]
    ds_write_b32 v56, v43 offset:4632
    s_mov_b64 exec, -1
    s_mov_b64 exec, -1
    s_waitcnt vmcnt(6)
    buffer_load_dwordx4 v2, s[4:7], s62 offen offset:1024 nt lds
    s_mov_b64 exec, -1
    s_waitcnt vmcnt(6)
    buffer_load_dwordx4 v2, s[4:7], s62 offen offset:2048 nt lds
    s_add_u32 s63, s63, s74
    s_mov_b32 exec_lo, 0x77777777
    s_mov_b32 exec_hi, 0x77777777
    s_waitcnt vmcnt(6)
    buffer_load_dwordx4 v[52:55], v60, s[84:87], s63 offen
    s_mov_b64 exec, -1
    s_waitcnt vmcnt(6)
    buffer_load_dwordx4 v2, s[4:7], s62 offen offset:3072 nt lds
    s_waitcnt vmcnt(8)
    s_mov_b64 exec, s[64:65]
    ds_write_b32 v56, v44 offset:5760
    s_mov_b64 exec, s[66:67]
    ds_write_b32 v56, v45 offset:5768
    s_mov_b64 exec, s[68:69]
    ds_write_b32 v56, v46 offset:5776
    s_mov_b64 exec, s[72:73]
    ds_write_b32 v56, v47 offset:5784
    s_mov_b64 exec, -1
    s_add_u32 m0, m0, 4096
    s_nop 0
    s_mov_b64 exec, -1
    s_waitcnt vmcnt(6)
    buffer_load_dwordx4 v3, s[8:11], s62 offen offset:0 nt lds
    s_add_u32 s63, s63, s74
    s_mov_b32 exec_lo, 0x77777777
    s_mov_b32 exec_hi, 0x77777777
    s_waitcnt vmcnt(6)
    buffer_load_dwordx4 v[24:27], v60, s[84:87], s63 offen
    s_mov_b64 exec, -1
    s_waitcnt vmcnt(6)
    buffer_load_dwordx4 v3, s[8:11], s62 offen offset:1024 nt lds
    s_waitcnt vmcnt(8)
    s_mov_b64 exec, s[64:65]
    ds_write_b32 v56, v48 offset:6912
    s_mov_b64 exec, s[66:67]
    ds_write_b32 v56, v49 offset:6920
    s_mov_b64 exec, s[68:69]
    ds_write_b32 v56, v50 offset:6928
    s_mov_b64 exec, s[72:73]
    ds_write_b32 v56, v51 offset:6936
    s_mov_b64 exec, -1
    s_mov_b64 exec, -1
    s_waitcnt vmcnt(6)
    buffer_load_dwordx4 v3, s[8:11], s62 offen offset:2048 nt lds
    s_mov_b64 exec, -1
    s_waitcnt vmcnt(6)
    buffer_load_dwordx4 v3, s[8:11], s62 offen offset:3072 nt lds
    s_add_u32 s63, s63, s74
    s_mov_b32 exec_lo, 0x77777777
    s_mov_b32 exec_hi, 0x77777777
    s_waitcnt vmcnt(6)
    buffer_load_dwordx4 v[28:31], v60, s[84:87], s63 offen
    s_add_u32 s62, s90, 786432
    s_mov_b64 exec, -1
    s_waitcnt vmcnt(6)
    buffer_load_dwordx4 a[0:3], v2, s[4:7], s62 offen offset:0 nt
    s_waitcnt vmcnt(8)
    s_mov_b64 exec, s[64:65]
    ds_write_b32 v56, v52 offset:8064
    s_mov_b64 exec, s[66:67]
    ds_write_b32 v56, v53 offset:8072
    s_mov_b64 exec, s[68:69]
    ds_write_b32 v56, v54 offset:8080
    s_mov_b64 exec, s[72:73]
    ds_write_b32 v56, v55 offset:8088
    s_mov_b64 exec, -1
    s_mov_b64 exec, -1
    s_waitcnt vmcnt(6)
    buffer_load_dwordx4 a[4:7], v2, s[4:7], s62 offen offset:1024 nt
    s_add_u32 s63, s63, s74
    s_mov_b32 exec_lo, 0x77777777
    s_mov_b32 exec_hi, 0x77777777
    s_waitcnt vmcnt(6)
    buffer_load_dwordx4 v[32:35], v60, s[84:87], s63 offen
    s_mov_b64 exec, -1
    s_waitcnt vmcnt(6)
    buffer_load_dwordx4 a[8:11], v2, s[4:7], s62 offen offset:2048 nt
    s_waitcnt vmcnt(8)
    s_mov_b64 exec, s[64:65]
    ds_write_b32 v56, v24 offset:9216
    s_mov_b64 exec, s[66:67]
    ds_write_b32 v56, v25 offset:9224
    s_mov_b64 exec, s[68:69]
    ds_write_b32 v56, v26 offset:9232
    s_mov_b64 exec, s[72:73]
    ds_write_b32 v56, v27 offset:9240
    s_mov_b64 exec, -1
    s_mov_b64 exec, -1
    s_waitcnt vmcnt(6)
    buffer_load_dwordx4 a[12:15], v2, s[4:7], s62 offen offset:3072 nt
    s_mov_b64 exec, -1
    s_waitcnt vmcnt(6)
    buffer_load_dwordx4 a[16:19], v3, s[8:11], s62 offen offset:0 nt
    s_mov_b64 exec, -1
    v_mul_u32_u24 v12, 6, v0
    buffer_load_ushort v8, v12, s[40:43], 0 offen offset:0
    buffer_load_ushort v9, v12, s[40:43], 0 offen offset:2
    buffer_load_ushort v10, v12, s[40:43], 0 offen offset:4
    s_add_u32 s63, s63, s74
    s_mov_b32 exec_lo, 0x77777777
    s_mov_b32 exec_hi, 0x77777777
    s_waitcnt vmcnt(6)
    buffer_load_dwordx4 v[36:39], v60, s[84:87], s63 offen
    s_waitcnt vmcnt(10)
    s_mov_b64 exec, s[64:65]
    ds_write_b32 v56, v28 offset:10368
    s_mov_b64 exec, s[66:67]
    ds_write_b32 v56, v29 offset:10376
    s_mov_b64 exec, s[68:69]
    ds_write_b32 v56, v30 offset:10384
    s_mov_b64 exec, s[72:73]
    ds_write_b32 v56, v31 offset:10392
    s_mov_b64 exec, -1
    s_mov_b64 exec, -1
    s_waitcnt vmcnt(6)
    buffer_load_dwordx4 a[20:23], v3, s[8:11], s62 offen offset:1024 nt
    s_waitcnt vmcnt(8)
    s_mov_b64 exec, s[64:65]
    ds_write_b32 v56, v32 offset:11520
    s_mov_b64 exec, s[66:67]
    ds_write_b32 v56, v33 offset:11528
    s_mov_b64 exec, s[68:69]
    ds_write_b32 v56, v34 offset:11536
    s_mov_b64 exec, s[72:73]
    ds_write_b32 v56, v35 offset:11544
    s_mov_b64 exec, -1
    s_mov_b64 exec, -1
    s_waitcnt vmcnt(6)
    buffer_load_dwordx4 a[24:27], v3, s[8:11], s62 offen offset:2048 nt
    s_add_u32 s63, s63, s74
    s_mov_b32 exec_lo, 0x77777777
    s_mov_b32 exec_hi, 0x77777777
    s_waitcnt vmcnt(6)
    buffer_load_dwordx4 v[40:43], v60, s[84:87], s63 offen
    s_mov_b64 exec, -1
    s_waitcnt vmcnt(6)
    buffer_load_dwordx4 a[28:31], v3, s[8:11], s62 offen offset:3072 nt
    s_add_u32 s62, s90, 802816
    s_mov_b64 exec, -1
    s_waitcnt vmcnt(6)
    buffer_load_dwordx4 a[32:35], v2, s[4:7], s62 offen offset:0 nt
    s_mov_b64 exec, -1
    s_waitcnt vmcnt(6)
    buffer_load_dwordx4 a[36:39], v2, s[4:7], s62 offen offset:1024 nt
    s_add_u32 s63, s63, s74
    s_mov_b32 exec_lo, 0x77777777
    s_mov_b32 exec_hi, 0x77777777
    s_waitcnt vmcnt(6)
    buffer_load_dwordx4 v[44:47], v60, s[84:87], s63 offen
    s_mov_b64 exec, -1
    s_waitcnt vmcnt(6)
    buffer_load_dwordx4 a[40:43], v2, s[4:7], s62 offen offset:2048 nt
    s_waitcnt vmcnt(8)
    s_mov_b64 exec, s[64:65]
    ds_write_b32 v56, v36 offset:12672
    s_mov_b64 exec, s[66:67]
    ds_write_b32 v56, v37 offset:12680
    s_mov_b64 exec, s[68:69]
    ds_write_b32 v56, v38 offset:12688
    s_mov_b64 exec, s[72:73]
    ds_write_b32 v56, v39 offset:12696
    s_mov_b64 exec, -1
    s_mov_b64 exec, -1
    s_waitcnt vmcnt(6)
    buffer_load_dwordx4 a[44:47], v2, s[4:7], s62 offen offset:3072 nt
    s_add_u32 s63, s63, s74
    s_mov_b32 exec_lo, 0x77777777
    s_mov_b32 exec_hi, 0x77777777
    s_waitcnt vmcnt(6)
    buffer_load_dwordx4 v[48:51], v60, s[84:87], s63 offen
    s_mov_b64 exec, -1
    s_waitcnt vmcnt(6)
    buffer_load_dwordx4 a[48:51], v3, s[8:11], s62 offen offset:0 nt
    s_waitcnt vmcnt(8)
    s_mov_b64 exec, s[64:65]
    ds_write_b32 v56, v40 offset:13824
    s_mov_b64 exec, s[66:67]
    ds_write_b32 v56, v41 offset:13832
    s_mov_b64 exec, s[68:69]
    ds_write_b32 v56, v42 offset:13840
    s_mov_b64 exec, s[72:73]
    ds_write_b32 v56, v43 offset:13848
    s_mov_b64 exec, -1
    s_mov_b64 exec, -1
    s_waitcnt vmcnt(6)
    buffer_load_dwordx4 a[52:55], v3, s[8:11], s62 offen offset:1024 nt
    s_mov_b64 exec, -1
    s_waitcnt vmcnt(6)
    buffer_load_dwordx4 a[56:59], v3, s[8:11], s62 offen offset:2048 nt
    s_add_u32 s63, s63, s74
    s_mov_b32 exec_lo, 0x77777777
    s_mov_b32 exec_hi, 0x77777777
    s_waitcnt vmcnt(6)
    buffer_load_dwordx4 v[52:55], v60, s[84:87], s63 offen
    s_mov_b64 exec, -1
    s_waitcnt vmcnt(6)
    buffer_load_dwordx4 a[60:63], v3, s[8:11], s62 offen offset:3072 nt
    s_waitcnt vmcnt(8)
    s_mov_b64 exec, s[64:65]
    ds_write_b32 v56, v44 offset:14976
    s_mov_b64 exec, s[66:67]
    ds_write_b32 v56, v45 offset:14984
    s_mov_b64 exec, s[68:69]
    ds_write_b32 v56, v46 offset:14992
    s_mov_b64 exec, s[72:73]
    ds_write_b32 v56, v47 offset:15000
    s_mov_b64 exec, -1
    s_add_u32 s62, s90, 819200
    s_mov_b64 exec, -1
    s_waitcnt vmcnt(6)
    buffer_load_dwordx4 a[64:67], v2, s[4:7], s62 offen offset:0 nt
    s_add_u32 s63, s63, s74
    s_mov_b32 exec_lo, 0x77777777
    s_mov_b32 exec_hi, 0x77777777
    s_waitcnt vmcnt(6)
    buffer_load_dwordx4 v[24:27], v60, s[84:87], s63 offen
    s_mov_b64 exec, -1
    s_waitcnt vmcnt(6)
    buffer_load_dwordx4 a[68:71], v2, s[4:7], s62 offen offset:1024 nt
    s_waitcnt vmcnt(8)
    s_mov_b64 exec, s[64:65]
    ds_write_b32 v56, v48 offset:16128
    s_mov_b64 exec, s[66:67]
    ds_write_b32 v56, v49 offset:16136
    s_mov_b64 exec, s[68:69]
    ds_write_b32 v56, v50 offset:16144
    s_mov_b64 exec, s[72:73]
    ds_write_b32 v56, v51 offset:16152
    s_mov_b64 exec, -1
    s_mov_b64 exec, -1
    s_waitcnt vmcnt(6)
    buffer_load_dwordx4 a[72:75], v2, s[4:7], s62 offen offset:2048 nt
    s_add_u32 s63, s63, s74
    s_mov_b32 exec_lo, 0x77777777
    s_mov_b32 exec_hi, 0x77777777
    s_waitcnt vmcnt(6)
    buffer_load_dwordx4 v[28:31], v60, s[84:87], s63 offen
    s_mov_b64 exec, -1
    s_waitcnt vmcnt(6)
    buffer_load_dwordx4 a[76:79], v2, s[4:7], s62 offen offset:3072 nt
    s_mov_b64 exec, -1
    s_waitcnt vmcnt(6)
    buffer_load_dwordx4 a[80:83], v3, s[8:11], s62 offen offset:0 nt
    s_waitcnt vmcnt(8)
    s_mov_b64 exec, s[64:65]
    ds_write_b32 v56, v52 offset:17280
    s_mov_b64 exec, s[66:67]
    ds_write_b32 v56, v53 offset:17288
    s_mov_b64 exec, s[68:69]
    ds_write_b32 v56, v54 offset:17296
    s_mov_b64 exec, s[72:73]
    ds_write_b32 v56, v55 offset:17304
    s_mov_b64 exec, -1
    s_mov_b64 exec, -1
    s_waitcnt vmcnt(6)
    buffer_load_dwordx4 a[84:87], v3, s[8:11], s62 offen offset:1024 nt
    s_add_u32 s63, s63, s74
    s_mov_b32 exec_lo, 0x77777777
    s_mov_b32 exec_hi, 0x77777777
    s_waitcnt vmcnt(6)
    buffer_load_dwordx4 v[32:35], v60, s[84:87], s63 offen
    s_mov_b64 exec, -1
    s_waitcnt vmcnt(6)
    buffer_load_dwordx4 a[88:91], v3, s[8:11], s62 offen offset:2048 nt
    s_waitcnt vmcnt(8)
    s_mov_b64 exec, s[64:65]
    ds_write_b32 v56, v24 offset:18432
    s_mov_b64 exec, s[66:67]
    ds_write_b32 v56, v25 offset:18440
    s_mov_b64 exec, s[68:69]
    ds_write_b32 v56, v26 offset:18448
    s_mov_b64 exec, s[72:73]
    ds_write_b32 v56, v27 offset:18456
    s_mov_b64 exec, -1
    s_mov_b64 exec, -1
    s_waitcnt vmcnt(6)
    buffer_load_dwordx4 a[92:95], v3, s[8:11], s62 offen offset:3072 nt
    s_add_u32 s63, s63, s74
    s_mov_b32 exec_lo, 0x77777777
    s_mov_b32 exec_hi, 0x77777777
    s_waitcnt vmcnt(6)
    buffer_load_dwordx4 v[36:39], v60, s[84:87], s63 offen
    s_add_u32 s62, s90, 835584
    s_mov_b64 exec, -1
    s_waitcnt vmcnt(6)
    buffer_load_dwordx4 a[96:99], v2, s[4:7], s62 offen offset:0 nt
    s_waitcnt vmcnt(8)
    s_mov_b64 exec, s[64:65]
    ds_write_b32 v56, v28 offset:19584
    s_mov_b64 exec, s[66:67]
    ds_write_b32 v56, v29 offset:19592
    s_mov_b64 exec, s[68:69]
    ds_write_b32 v56, v30 offset:19600
    s_mov_b64 exec, s[72:73]
    ds_write_b32 v56, v31 offset:19608
    s_mov_b64 exec, -1
    s_mov_b64 exec, -1
    s_waitcnt vmcnt(6)
    buffer_load_dwordx4 a[100:103], v2, s[4:7], s62 offen offset:1024 nt
    s_mov_b64 exec, -1
    s_waitcnt vmcnt(6)
    buffer_load_dwordx4 a[104:107], v2, s[4:7], s62 offen offset:2048 nt
    s_add_u32 s63, s63, s74
    s_mov_b32 exec_lo, 0x77777777
    s_mov_b32 exec_hi, 0x77777777
    s_waitcnt vmcnt(6)
    buffer_load_dwordx4 v[40:43], v60, s[84:87], s63 offen
    s_mov_b64 exec, -1
    s_waitcnt vmcnt(6)
    buffer_load_dwordx4 a[108:111], v2, s[4:7], s62 offen offset:3072 nt
    s_waitcnt vmcnt(8)
    s_mov_b64 exec, s[64:65]
    ds_write_b32 v57, v32 offset:0
    s_mov_b64 exec, s[66:67]
    ds_write_b32 v57, v33 offset:8
    s_mov_b64 exec, s[68:69]
    ds_write_b32 v57, v34 offset:16
    s_mov_b64 exec, s[72:73]
    ds_write_b32 v57, v35 offset:24
    s_mov_b64 exec, -1
    s_mov_b64 exec, -1
    s_waitcnt vmcnt(6)
    buffer_load_dwordx4 a[112:115], v3, s[8:11], s62 offen offset:0 nt
    s_add_u32 s63, s63, s74
    s_mov_b32 exec_lo, 0x77777777
    s_mov_b32 exec_hi, 0x77777777
    s_waitcnt vmcnt(6)
    buffer_load_dwordx4 v[44:47], v60, s[84:87], s63 offen
    s_mov_b64 exec, -1
    s_waitcnt vmcnt(6)
    buffer_load_dwordx4 a[116:119], v3, s[8:11], s62 offen offset:1024 nt
    s_waitcnt vmcnt(8)
    s_mov_b64 exec, s[64:65]
    ds_write_b32 v57, v36 offset:1152
    s_mov_b64 exec, s[66:67]
    ds_write_b32 v57, v37 offset:1160
    s_mov_b64 exec, s[68:69]
    ds_write_b32 v57, v38 offset:1168
    s_mov_b64 exec, s[72:73]
    ds_write_b32 v57, v39 offset:1176
    s_mov_b64 exec, -1
    s_mov_b64 exec, -1
    s_waitcnt vmcnt(6)
    buffer_load_dwordx4 a[120:123], v3, s[8:11], s62 offen offset:2048 nt
    s_mov_b64 exec, -1
    s_waitcnt vmcnt(6)
    buffer_load_dwordx4 a[124:127], v3, s[8:11], s62 offen offset:3072 nt
    s_add_u32 s63, s63, s74
    s_mov_b32 exec_lo, 0x77777777
    s_mov_b32 exec_hi, 0x77777777
    s_waitcnt vmcnt(6)
    buffer_load_dwordx4 v[48:51], v60, s[84:87], s63 offen
    s_add_u32 s62, s90, 851968
    s_mov_b64 exec, -1
    s_waitcnt vmcnt(6)
    buffer_load_dwordx4 a[128:131], v2, s[4:7], s62 offen offset:0 nt
    s_waitcnt vmcnt(8)
    s_mov_b64 exec, s[64:65]
    ds_write_b32 v57, v40 offset:2304
    s_mov_b64 exec, s[66:67]
    ds_write_b32 v57, v41 offset:2312
    s_mov_b64 exec, s[68:69]
    ds_write_b32 v57, v42 offset:2320
    s_mov_b64 exec, s[72:73]
    ds_write_b32 v57, v43 offset:2328
    s_mov_b64 exec, -1
    s_mov_b64 exec, -1
    s_waitcnt vmcnt(6)
    buffer_load_dwordx4 a[132:135], v2, s[4:7], s62 offen offset:1024 nt
    s_add_u32 s63, s63, s74
    s_mov_b32 exec_lo, 0x77777777
    s_mov_b32 exec_hi, 0x77777777
    s_waitcnt vmcnt(6)
    buffer_load_dwordx4 v[52:55], v60, s[84:87], s63 offen
    s_mov_b64 exec, -1
    s_waitcnt vmcnt(6)
    buffer_load_dwordx4 a[136:139], v2, s[4:7], s62 offen offset:2048 nt
    s_waitcnt vmcnt(8)
    s_mov_b64 exec, s[64:65]
    ds_write_b32 v57, v44 offset:3456
    s_mov_b64 exec, s[66:67]
    ds_write_b32 v57, v45 offset:3464
    s_mov_b64 exec, s[68:69]
    ds_write_b32 v57, v46 offset:3472
    s_mov_b64 exec, s[72:73]
    ds_write_b32 v57, v47 offset:3480
    s_mov_b64 exec, -1
    s_mov_b64 exec, -1
    s_waitcnt vmcnt(6)
    buffer_load_dwordx4 a[140:143], v2, s[4:7], s62 offen offset:3072 nt
    s_mov_b64 exec, -1
    s_waitcnt vmcnt(6)
    buffer_load_dwordx4 a[144:147], v3, s[8:11], s62 offen offset:0 nt
    s_add_u32 s63, s63, s74
    s_mov_b32 exec_lo, 0x77777777
    s_mov_b32 exec_hi, 0x77777777
    s_waitcnt vmcnt(6)
    buffer_load_dwordx4 v[24:27], v60, s[84:87], s63 offen
    s_mov_b64 exec, -1
    s_waitcnt vmcnt(6)
    buffer_load_dwordx4 a[148:151], v3, s[8:11], s62 offen offset:1024 nt
    s_waitcnt vmcnt(8)
    s_mov_b64 exec, s[64:65]
    ds_write_b32 v57, v48 offset:4608
    s_mov_b64 exec, s[66:67]
    ds_write_b32 v57, v49 offset:4616
    s_mov_b64 exec, s[68:69]
    ds_write_b32 v57, v50 offset:4624
    s_mov_b64 exec, s[72:73]
    ds_write_b32 v57, v51 offset:4632
    s_mov_b64 exec, -1
    s_mov_b64 exec, -1
    s_waitcnt vmcnt(6)
    buffer_load_dwordx4 a[152:155], v3, s[8:11], s62 offen offset:2048 nt
    s_add_u32 s63, s63, s74
    s_mov_b32 exec_lo, 0x77777777
    s_mov_b32 exec_hi, 0x77777777
    s_waitcnt vmcnt(6)
    buffer_load_dwordx4 v[28:31], v60, s[84:87], s63 offen
    s_mov_b64 exec, -1
    s_waitcnt vmcnt(6)
    buffer_load_dwordx4 a[156:159], v3, s[8:11], s62 offen offset:3072 nt
    s_waitcnt vmcnt(8)
    s_mov_b64 exec, s[64:65]
    ds_write_b32 v57, v52 offset:5760
    s_mov_b64 exec, s[66:67]
    ds_write_b32 v57, v53 offset:5768
    s_mov_b64 exec, s[68:69]
    ds_write_b32 v57, v54 offset:5776
    s_mov_b64 exec, s[72:73]
    ds_write_b32 v57, v55 offset:5784
    s_mov_b64 exec, -1
    s_add_u32 s62, s90, 868352
    s_mov_b64 exec, -1
    s_waitcnt vmcnt(6)
    buffer_load_dwordx4 a[160:163], v2, s[4:7], s62 offen offset:0 nt
    s_mov_b64 exec, -1
    s_waitcnt vmcnt(6)
    buffer_load_dwordx4 a[164:167], v2, s[4:7], s62 offen offset:1024 nt
    s_add_u32 s63, s63, s74
    s_mov_b32 exec_lo, 0x77777777
    s_mov_b32 exec_hi, 0x77777777
    s_waitcnt vmcnt(6)
    buffer_load_dwordx4 v[32:35], v60, s[84:87], s63 offen
    s_mov_b64 exec, -1
    s_waitcnt vmcnt(6)
    buffer_load_dwordx4 a[168:171], v2, s[4:7], s62 offen offset:2048 nt
    s_waitcnt vmcnt(8)
    s_mov_b64 exec, s[64:65]
    ds_write_b32 v57, v24 offset:6912
    s_mov_b64 exec, s[66:67]
    ds_write_b32 v57, v25 offset:6920
    s_mov_b64 exec, s[68:69]
    ds_write_b32 v57, v26 offset:6928
    s_mov_b64 exec, s[72:73]
    ds_write_b32 v57, v27 offset:6936
    s_mov_b64 exec, -1
    s_mov_b64 exec, -1
    s_waitcnt vmcnt(6)
    buffer_load_dwordx4 a[172:175], v2, s[4:7], s62 offen offset:3072 nt
    s_add_u32 s63, s63, s74
    s_mov_b32 exec_lo, 0x77777777
    s_mov_b32 exec_hi, 0x77777777
    s_waitcnt vmcnt(6)
    buffer_load_dwordx4 v[36:39], v60, s[84:87], s63 offen
    s_mov_b64 exec, -1
    s_waitcnt vmcnt(6)
    buffer_load_dwordx4 a[176:179], v3, s[8:11], s62 offen offset:0 nt
    s_waitcnt vmcnt(8)
    s_mov_b64 exec, s[64:65]
    ds_write_b32 v57, v28 offset:8064
    s_mov_b64 exec, s[66:67]
    ds_write_b32 v57, v29 offset:8072
    s_mov_b64 exec, s[68:69]
    ds_write_b32 v57, v30 offset:8080
    s_mov_b64 exec, s[72:73]
    ds_write_b32 v57, v31 offset:8088
    s_mov_b64 exec, -1
    s_mov_b64 exec, -1
    s_waitcnt vmcnt(6)
    buffer_load_dwordx4 a[180:183], v3, s[8:11], s62 offen offset:1024 nt
    s_mov_b64 exec, -1
    s_waitcnt vmcnt(6)
    buffer_load_dwordx4 a[184:187], v3, s[8:11], s62 offen offset:2048 nt
    s_add_u32 s63, s63, s74
    s_mov_b32 exec_lo, 0x77777777
    s_mov_b32 exec_hi, 0x77777777
    s_waitcnt vmcnt(6)
    buffer_load_dwordx4 v[40:43], v60, s[84:87], s63 offen
    s_mov_b64 exec, -1
    s_waitcnt vmcnt(6)
    buffer_load_dwordx4 a[188:191], v3, s[8:11], s62 offen offset:3072 nt
    s_waitcnt vmcnt(8)
    s_mov_b64 exec, s[64:65]
    ds_write_b32 v57, v32 offset:9216
    s_mov_b64 exec, s[66:67]
    ds_write_b32 v57, v33 offset:9224
    s_mov_b64 exec, s[68:69]
    ds_write_b32 v57, v34 offset:9232
    s_mov_b64 exec, s[72:73]
    ds_write_b32 v57, v35 offset:9240
    s_mov_b64 exec, -1
    s_add_u32 s62, s90, 884736
    s_mov_b64 exec, -1
    s_waitcnt vmcnt(6)
    buffer_load_dwordx4 a[192:195], v2, s[4:7], s62 offen offset:0 nt
    s_add_u32 s63, s63, s74
    s_mov_b32 exec_lo, 0x77777777
    s_mov_b32 exec_hi, 0x77777777
    s_waitcnt vmcnt(6)
    buffer_load_dwordx4 v[44:47], v60, s[84:87], s63 offen
    s_mov_b64 exec, -1
    s_waitcnt vmcnt(6)
    buffer_load_dwordx4 a[196:199], v2, s[4:7], s62 offen offset:1024 nt
    s_waitcnt vmcnt(8)
    s_mov_b64 exec, s[64:65]
    ds_write_b32 v57, v36 offset:10368
    s_mov_b64 exec, s[66:67]
    ds_write_b32 v57, v37 offset:10376
    s_mov_b64 exec, s[68:69]
    ds_write_b32 v57, v38 offset:10384
    s_mov_b64 exec, s[72:73]
    ds_write_b32 v57, v39 offset:10392
    s_mov_b64 exec, -1
    s_mov_b64 exec, -1
    s_waitcnt vmcnt(6)
    buffer_load_dwordx4 a[200:203], v2, s[4:7], s62 offen offset:2048 nt
    s_mov_b64 exec, -1
    s_waitcnt vmcnt(6)
    buffer_load_dwordx4 a[204:207], v2, s[4:7], s62 offen offset:3072 nt
    s_add_u32 s63, s63, s74
    s_mov_b32 exec_lo, 0x77777777
    s_mov_b32 exec_hi, 0x77777777
    s_waitcnt vmcnt(6)
    buffer_load_dwordx4 v[48:51], v60, s[84:87], s63 offen
    s_mov_b64 exec, -1
    s_waitcnt vmcnt(6)
    buffer_load_dwordx4 a[208:211], v3, s[8:11], s62 offen offset:0 nt
    s_waitcnt vmcnt(8)
    s_mov_b64 exec, s[64:65]
    ds_write_b32 v57, v40 offset:11520
    s_mov_b64 exec, s[66:67]
    ds_write_b32 v57, v41 offset:11528
    s_mov_b64 exec, s[68:69]
    ds_write_b32 v57, v42 offset:11536
    s_mov_b64 exec, s[72:73]
    ds_write_b32 v57, v43 offset:11544
    s_mov_b64 exec, -1
    s_mov_b64 exec, -1
    s_waitcnt vmcnt(6)
    buffer_load_dwordx4 a[212:215], v3, s[8:11], s62 offen offset:1024 nt
    s_add_u32 s63, s63, s74
    s_mov_b32 exec_lo, 0x77777777
    s_mov_b32 exec_hi, 0x77777777
    s_waitcnt vmcnt(6)
    buffer_load_dwordx4 v[52:55], v60, s[84:87], s63 offen
    s_mov_b64 exec, -1
    s_waitcnt vmcnt(6)
    buffer_load_dwordx4 a[216:219], v3, s[8:11], s62 offen offset:2048 nt
    s_waitcnt vmcnt(8)
    s_mov_b64 exec, s[64:65]
    ds_write_b32 v57, v44 offset:12672
    s_mov_b64 exec, s[66:67]
    ds_write_b32 v57, v45 offset:12680
    s_mov_b64 exec, s[68:69]
    ds_write_b32 v57, v46 offset:12688
    s_mov_b64 exec, s[72:73]
    ds_write_b32 v57, v47 offset:12696
    s_mov_b64 exec, -1
    s_mov_b64 exec, -1
    s_waitcnt vmcnt(6)
    buffer_load_dwordx4 a[220:223], v3, s[8:11], s62 offen offset:3072 nt
    s_add_u32 s63, s63, s74
    s_mov_b32 exec_lo, 0x77777777
    s_mov_b32 exec_hi, 0x77777777
    s_waitcnt vmcnt(6)
    buffer_load_dwordx4 v[24:27], v60, s[84:87], s63 offen
    s_add_u32 s62, s90, 901120
    s_mov_b64 exec, -1
    s_waitcnt vmcnt(6)
    buffer_load_dwordx4 a[224:227], v2, s[4:7], s62 offen offset:0 nt
    s_mov_b64 exec, -1
    s_waitcnt vmcnt(6)
    buffer_load_dwordx4 a[228:231], v2, s[4:7], s62 offen offset:1024 nt
    s_waitcnt vmcnt(8)
    s_mov_b64 exec, s[64:65]
    ds_write_b32 v57, v48 offset:13824
    s_mov_b64 exec, s[66:67]
    ds_write_b32 v57, v49 offset:13832
    s_mov_b64 exec, s[68:69]
    ds_write_b32 v57, v50 offset:13840
    s_mov_b64 exec, s[72:73]
    ds_write_b32 v57, v51 offset:13848
    s_mov_b64 exec, -1
    s_mov_b64 exec, -1
    s_waitcnt vmcnt(6)
    buffer_load_dwordx4 a[232:235], v2, s[4:7], s62 offen offset:2048 nt
    s_add_u32 s63, s63, s74
    s_mov_b32 exec_lo, 0x77777777
    s_mov_b32 exec_hi, 0x77777777
    s_waitcnt vmcnt(6)
    buffer_load_dwordx4 v[28:31], v60, s[84:87], s63 offen
    s_mov_b64 exec, -1
    s_waitcnt vmcnt(6)
    buffer_load_dwordx4 a[236:239], v2, s[4:7], s62 offen offset:3072 nt
    s_waitcnt vmcnt(8)
    s_mov_b64 exec, s[64:65]
    ds_write_b32 v57, v52 offset:14976
    s_mov_b64 exec, s[66:67]
    ds_write_b32 v57, v53 offset:14984
    s_mov_b64 exec, s[68:69]
    ds_write_b32 v57, v54 offset:14992
    s_mov_b64 exec, s[72:73]
    ds_write_b32 v57, v55 offset:15000
    s_mov_b64 exec, -1
    s_mov_b64 exec, -1
    s_waitcnt vmcnt(6)
    buffer_load_dwordx4 a[240:243], v3, s[8:11], s62 offen offset:0 nt
    s_add_u32 s63, s63, s74
    s_mov_b32 exec_lo, 0x77777777
    s_mov_b32 exec_hi, 0x77777777
    s_waitcnt vmcnt(6)
    buffer_load_dwordx4 v[32:35], v60, s[84:87], s63 offen
    s_mov_b64 exec, -1
    s_waitcnt vmcnt(6)
    buffer_load_dwordx4 a[244:247], v3, s[8:11], s62 offen offset:1024 nt
    s_waitcnt vmcnt(8)
    s_mov_b64 exec, s[64:65]
    ds_write_b32 v57, v24 offset:16128
    s_mov_b64 exec, s[66:67]
    ds_write_b32 v57, v25 offset:16136
    s_mov_b64 exec, s[68:69]
    ds_write_b32 v57, v26 offset:16144
    s_mov_b64 exec, s[72:73]
    ds_write_b32 v57, v27 offset:16152
    s_mov_b64 exec, -1
    s_mov_b64 exec, -1
    s_waitcnt vmcnt(6)
    buffer_load_dwordx4 a[248:251], v3, s[8:11], s62 offen offset:2048 nt
    s_mov_b64 exec, -1
    s_waitcnt vmcnt(6)
    buffer_load_dwordx4 a[252:255], v3, s[8:11], s62 offen offset:3072 nt
    s_add_u32 s63, s63, s74
    s_mov_b32 exec_lo, 0x77777777
    s_mov_b32 exec_hi, 0x77777777
    s_waitcnt vmcnt(6)
    buffer_load_dwordx4 v[36:39], v60, s[84:87], s63 offen
    s_add_u32 s62, s90, 917504
    s_mov_b64 exec, -1
    s_waitcnt vmcnt(6)
    buffer_load_dwordx4 v[64:67], v2, s[4:7], s62 offen offset:0 nt
    s_waitcnt vmcnt(8)
    s_mov_b64 exec, s[64:65]
    ds_write_b32 v57, v28 offset:17280
    s_mov_b64 exec, s[66:67]
    ds_write_b32 v57, v29 offset:17288
    s_mov_b64 exec, s[68:69]
    ds_write_b32 v57, v30 offset:17296
    s_mov_b64 exec, s[72:73]
    ds_write_b32 v57, v31 offset:17304
    s_mov_b64 exec, -1
    s_mov_b64 exec, -1
    s_waitcnt vmcnt(6)
    buffer_load_dwordx4 v[68:71], v2, s[4:7], s62 offen offset:1024 nt
    s_sub_u32 s63, s3, 1
    s_mul_i32 s63, s63, 202752
    s_mov_b32 exec_lo, 0x77777777
    s_mov_b32 exec_hi, 0x77777777
    s_waitcnt vmcnt(6)
    buffer_load_dwordx4 v[40:43], v61, s[24:27], s63 offen
    s_mov_b64 exec, -1
    s_waitcnt vmcnt(6)
    buffer_load_dwordx4 v[72:75], v2, s[4:7], s62 offen offset:2048 nt
    s_waitcnt vmcnt(8)
    s_mov_b64 exec, s[64:65]
    ds_write_b32 v57, v32 offset:18432
    s_mov_b64 exec, s[66:67]
    ds_write_b32 v57, v33 offset:18440
    s_mov_b64 exec, s[68:69]
    ds_write_b32 v57, v34 offset:18448
    s_mov_b64 exec, s[72:73]
    ds_write_b32 v57, v35 offset:18456
    s_mov_b64 exec, -1
    s_mov_b64 exec, -1
    s_waitcnt vmcnt(6)
    buffer_load_dwordx4 v[76:79], v2, s[4:7], s62 offen offset:3072 nt
    s_mov_b64 exec, -1
    s_waitcnt vmcnt(6)
    buffer_load_dwordx4 v[80:83], v3, s[8:11], s62 offen offset:0 nt
    s_add_u32 s63, s63, 18432
    s_mov_b32 exec_lo, 0x77777777
    s_mov_b32 exec_hi, 0x77777777
    s_waitcnt vmcnt(6)
    buffer_load_dwordx4 v[44:47], v61, s[24:27], s63 offen
    s_mov_b64 exec, -1
    s_waitcnt vmcnt(6)
    buffer_load_dwordx4 v[84:87], v3, s[8:11], s62 offen offset:1024 nt
    s_waitcnt vmcnt(8)
    s_mov_b64 exec, s[64:65]
    ds_write_b32 v57, v36 offset:19584
    s_mov_b64 exec, s[66:67]
    ds_write_b32 v57, v37 offset:19592
    s_mov_b64 exec, s[68:69]
    ds_write_b32 v57, v38 offset:19600
    s_mov_b64 exec, s[72:73]
    ds_write_b32 v57, v39 offset:19608
    s_mov_b64 exec, -1
    s_mov_b64 exec, -1
    s_waitcnt vmcnt(6)
    buffer_load_dwordx4 v[88:91], v3, s[8:11], s62 offen offset:2048 nt
    s_add_u32 s63, s63, 18432
    s_mov_b32 exec_lo, 0x77777777
    s_mov_b32 exec_hi, 0x77777777
    s_waitcnt vmcnt(6)
    buffer_load_dwordx4 v[48:51], v61, s[24:27], s63 offen
    s_mov_b64 exec, -1
    s_waitcnt vmcnt(6)
    buffer_load_dwordx4 v[92:95], v3, s[8:11], s62 offen offset:3072 nt
    s_waitcnt vmcnt(8)
    s_mov_b64 exec, -1
    s_mov_b32 s61, s75
    v_add_u32 v18, 0, v17
    v_subrev_u32 v18, s61, v18
    v_cmp_gt_u32 s[64:65], 9, v18
    v_add_u32 v18, 1, v17
    v_subrev_u32 v18, s61, v18
    v_cmp_gt_u32 s[66:67], 9, v18
    v_add_u32 v18, 2, v17
    v_subrev_u32 v18, s61, v18
    v_cmp_gt_u32 s[68:69], 9, v18
    v_add_u32 v18, 3, v17
    v_subrev_u32 v18, s61, v18
    v_cmp_gt_u32 s[72:73], 9, v18
    s_mul_i32 s52, s3, 11
    s_sub_u32 s53, s52, 11
    s_and_b32 s52, s53, 15
    s_mul_i32 s52, s52, 1152
    s_lshr_b32 s53, s53, 4
    s_lshl_b32 s53, s53, 2
    s_add_u32 s52, s52, s53
    v_add_u32 v59, s52, v58
    s_mov_b64 exec, s[64:65]
    ds_write_b32 v59, v40 offset:0
    s_mov_b64 exec, s[66:67]
    ds_write_b32 v59, v41 offset:8
    s_mov_b64 exec, s[68:69]
    ds_write_b32 v59, v42 offset:16
    s_mov_b64 exec, s[72:73]
    ds_write_b32 v59, v43 offset:24
L_wo_3:
    s_mov_b64 exec, -1
    s_add_u32 s62, s90, 933888
    s_mov_b64 exec, -1
    s_waitcnt vmcnt(6)
    buffer_load_dwordx4 v[96:99], v2, s[4:7], s62 offen offset:0 nt
    s_mov_b64 exec, -1
    s_waitcnt vmcnt(6)
    buffer_load_dwordx4 v[100:103], v2, s[4:7], s62 offen offset:1024 nt
    s_add_u32 s63, s63, 18432
    s_mov_b32 exec_lo, 0x77777777
    s_mov_b32 exec_hi, 0x77777777
    s_waitcnt vmcnt(6)
    buffer_load_dwordx4 v[52:55], v61, s[24:27], s63 offen
    s_mov_b64 exec, -1
    s_waitcnt vmcnt(6)
    buffer_load_dwordx4 v[104:107], v2, s[4:7], s62 offen offset:2048 nt
    s_waitcnt vmcnt(8)
    s_mov_b64 exec, -1
    s_mul_i32 s52, s3, 11
    s_sub_u32 s53, s52, 10
    s_and_b32 s52, s53, 15
    s_mul_i32 s52, s52, 1152
    s_lshr_b32 s53, s53, 4
    s_lshl_b32 s53, s53, 2
    s_add_u32 s52, s52, s53
    v_add_u32 v59, s52, v58
    s_mov_b64 exec, s[64:65]
    ds_write_b32 v59, v44 offset:0
    s_mov_b64 exec, s[66:67]
    ds_write_b32 v59, v45 offset:8
    s_mov_b64 exec, s[68:69]
    ds_write_b32 v59, v46 offset:16
    s_mov_b64 exec, s[72:73]
    ds_write_b32 v59, v47 offset:24
L_wo_4:
    s_mov_b64 exec, -1
    s_mov_b64 exec, -1
    s_waitcnt vmcnt(6)
    buffer_load_dwordx4 v[108:111], v2, s[4:7], s62 offen offset:3072 nt
    s_add_u32 s63, s63, 18432
    s_mov_b32 exec_lo, 0x77777777
    s_mov_b32 exec_hi, 0x77777777
    s_waitcnt vmcnt(6)
    buffer_load_dwordx4 v[24:27], v61, s[24:27], s63 offen
    s_mov_b64 exec, -1
    s_waitcnt vmcnt(6)
    buffer_load_dwordx4 v[112:115], v3, s[8:11], s62 offen offset:0 nt
    s_waitcnt vmcnt(8)
    s_mov_b64 exec, -1
    s_mul_i32 s52, s3, 11
    s_sub_u32 s53, s52, 9
    s_and_b32 s52, s53, 15
    s_mul_i32 s52, s52, 1152
    s_lshr_b32 s53, s53, 4
    s_lshl_b32 s53, s53, 2
    s_add_u32 s52, s52, s53
    v_add_u32 v59, s52, v58
    s_mov_b64 exec, s[64:65]
    ds_write_b32 v59, v48 offset:0
    s_mov_b64 exec, s[66:67]
    ds_write_b32 v59, v49 offset:8
    s_mov_b64 exec, s[68:69]
    ds_write_b32 v59, v50 offset:16
    s_mov_b64 exec, s[72:73]
    ds_write_b32 v59, v51 offset:24
L_wo_5:
    s_mov_b64 exec, -1
    s_mov_b64 exec, -1
    s_waitcnt vmcnt(6)
    buffer_load_dwordx4 v[116:119], v3, s[8:11], s62 offen offset:1024 nt
    s_mov_b64 exec, -1
    s_waitcnt vmcnt(6)
    buffer_load_dwordx4 v[120:123], v3, s[8:11], s62 offen offset:2048 nt
    s_add_u32 s63, s63, 18432
    s_mov_b32 exec_lo, 0x77777777
    s_mov_b32 exec_hi, 0x77777777
    s_waitcnt vmcnt(6)
    buffer_load_dwordx4 v[28:31], v61, s[24:27], s63 offen
    s_mov_b64 exec, -1
    s_waitcnt vmcnt(6)
    buffer_load_dwordx4 v[124:127], v3, s[8:11], s62 offen offset:3072 nt
    s_waitcnt vmcnt(8)
    s_mov_b64 exec, -1
    s_mul_i32 s52, s3, 11
    s_sub_u32 s53, s52, 8
    s_and_b32 s52, s53, 15
    s_mul_i32 s52, s52, 1152
    s_lshr_b32 s53, s53, 4
    s_lshl_b32 s53, s53, 2
    s_add_u32 s52, s52, s53
    v_add_u32 v59, s52, v58
    s_mov_b64 exec, s[64:65]
    ds_write_b32 v59, v52 offset:0
    s_mov_b64 exec, s[66:67]
    ds_write_b32 v59, v53 offset:8
    s_mov_b64 exec, s[68:69]
    ds_write_b32 v59, v54 offset:16
    s_mov_b64 exec, s[72:73]
    ds_write_b32 v59, v55 offset:24
L_wo_6:
    s_mov_b64 exec, -1
    s_add_u32 s62, s90, 950272
    s_mov_b64 exec, -1
    s_waitcnt vmcnt(6)
    buffer_load_dwordx4 v[128:131], v2, s[4:7], s62 offen offset:0 nt
    s_add_u32 s63, s63, 18432
    s_mov_b32 exec_lo, 0x77777777
    s_mov_b32 exec_hi, 0x77777777
    s_waitcnt vmcnt(6)
    buffer_load_dwordx4 v[32:35], v61, s[24:27], s63 offen
    s_mov_b64 exec, -1
    s_waitcnt vmcnt(6)
    buffer_load_dwordx4 v[132:135], v2, s[4:7], s62 offen offset:1024 nt
    s_waitcnt vmcnt(8)
    s_mov_b64 exec, -1
    s_mul_i32 s52, s3, 11
    s_sub_u32 s53, s52, 7
    s_and_b32 s52, s53, 15
    s_mul_i32 s52, s52, 1152
    s_lshr_b32 s53, s53, 4
    s_lshl_b32 s53, s53, 2
    s_add_u32 s52, s52, s53
    v_add_u32 v59, s52, v58
    s_mov_b64 exec, s[64:65]
    ds_write_b32 v59, v24 offset:0
    s_mov_b64 exec, s[66:67]
    ds_write_b32 v59, v25 offset:8
    s_mov_b64 exec, s[68:69]
    ds_write_b32 v59, v26 offset:16
    s_mov_b64 exec, s[72:73]
    ds_write_b32 v59, v27 offset:24
L_wo_7:
    s_mov_b64 exec, -1
    s_mov_b64 exec, -1
    s_waitcnt vmcnt(6)
    buffer_load_dwordx4 v[136:139], v2, s[4:7], s62 offen offset:2048 nt
    s_mov_b64 exec, -1
    s_waitcnt vmcnt(6)
    buffer_load_dwordx4 v[140:143], v2, s[4:7], s62 offen offset:3072 nt
    s_add_u32 s63, s63, 18432
    s_mov_b32 exec_lo, 0x77777777
    s_mov_b32 exec_hi, 0x77777777
    s_waitcnt vmcnt(6)
    buffer_load_dwordx4 v[36:39], v61, s[24:27], s63 offen
    s_mov_b64 exec, -1
    s_waitcnt vmcnt(6)
    buffer_load_dwordx4 v[144:147], v3, s[8:11], s62 offen offset:0 nt
    s_waitcnt vmcnt(8)
    s_mov_b64 exec, -1
    s_mul_i32 s52, s3, 11
    s_sub_u32 s53, s52, 6
    s_and_b32 s52, s53, 15
    s_mul_i32 s52, s52, 1152
    s_lshr_b32 s53, s53, 4
    s_lshl_b32 s53, s53, 2
    s_add_u32 s52, s52, s53
    v_add_u32 v59, s52, v58
    s_mov_b64 exec, s[64:65]
    ds_write_b32 v59, v28 offset:0
    s_mov_b64 exec, s[66:67]
    ds_write_b32 v59, v29 offset:8
    s_mov_b64 exec, s[68:69]
    ds_write_b32 v59, v30 offset:16
    s_mov_b64 exec, s[72:73]
    ds_write_b32 v59, v31 offset:24
L_wo_8:
    s_mov_b64 exec, -1
    s_mov_b64 exec, -1
    s_waitcnt vmcnt(6)
    buffer_load_dwordx4 v[148:151], v3, s[8:11], s62 offen offset:1024 nt
    s_add_u32 s63, s63, 18432
    s_mov_b32 exec_lo, 0x77777777
    s_mov_b32 exec_hi, 0x77777777
    s_waitcnt vmcnt(6)
    buffer_load_dwordx4 v[40:43], v61, s[24:27], s63 offen
    s_mov_b64 exec, -1
    s_waitcnt vmcnt(6)
    buffer_load_dwordx4 v[152:155], v3, s[8:11], s62 offen offset:2048 nt
    s_waitcnt vmcnt(8)
    s_mov_b64 exec, -1
    s_mul_i32 s52, s3, 11
    s_sub_u32 s53, s52, 5
    s_and_b32 s52, s53, 15
    s_mul_i32 s52, s52, 1152
    s_lshr_b32 s53, s53, 4
    s_lshl_b32 s53, s53, 2
    s_add_u32 s52, s52, s53
    v_add_u32 v59, s52, v58
    s_mov_b64 exec, s[64:65]
    ds_write_b32 v59, v32 offset:0
    s_mov_b64 exec, s[66:67]
    ds_write_b32 v59, v33 offset:8
    s_mov_b64 exec, s[68:69]
    ds_write_b32 v59, v34 offset:16
    s_mov_b64 exec, s[72:73]
    ds_write_b32 v59, v35 offset:24
L_wo_9:
    s_mov_b64 exec, -1
    s_mov_b64 exec, -1
    s_waitcnt vmcnt(6)
    buffer_load_dwordx4 v[156:159], v3, s[8:11], s62 offen offset:3072 nt
    s_add_u32 s62, s90, 966656
    s_mov_b64 exec, -1
    s_waitcnt vmcnt(6)
    buffer_load_dwordx4 v[160:163], v2, s[4:7], s62 offen offset:0 nt
    s_add_u32 s63, s63, 18432
    s_mov_b32 exec_lo, 0x77777777
    s_mov_b32 exec_hi, 0x77777777
    s_waitcnt vmcnt(6)
    buffer_load_dwordx4 v[44:47], v61, s[24:27], s63 offen
    s_mov_b64 exec, -1
    s_waitcnt vmcnt(6)
    buffer_load_dwordx4 v[164:167], v2, s[4:7], s62 offen offset:1024 nt
    s_waitcnt vmcnt(8)
    s_mov_b64 exec, -1
    s_mul_i32 s52, s3, 11
    s_sub_u32 s53, s52, 4
    s_and_b32 s52, s53, 15
    s_mul_i32 s52, s52, 1152
    s_lshr_b32 s53, s53, 4
    s_lshl_b32 s53, s53, 2
    s_add_u32 s52, s52, s53
    v_add_u32 v59, s52, v58
    s_mov_b64 exec, s[64:65]
    ds_write_b32 v59, v36 offset:0
    s_mov_b64 exec, s[66:67]
    ds_write_b32 v59, v37 offset:8
    s_mov_b64 exec, s[68:69]
    ds_write_b32 v59, v38 offset:16
    s_mov_b64 exec, s[72:73]
    ds_write_b32 v59, v39 offset:24
L_wo_10:
    s_mov_b64 exec, -1
    s_mov_b64 exec, -1
    s_waitcnt vmcnt(6)
    buffer_load_dwordx4 v[168:171], v2, s[4:7], s62 offen offset:2048 nt
    s_add_u32 s63, s63, 18432
    s_mov_b32 exec_lo, 0x77777777
    s_mov_b32 exec_hi, 0x77777777
    s_waitcnt vmcnt(6)
    buffer_load_dwordx4 v[48:51], v61, s[24:27], s63 offen
    s_mov_b64 exec, -1
    s_waitcnt vmcnt(6)
    buffer_load_dwordx4 v[172:175], v2, s[4:7], s62 offen offset:3072 nt
    s_waitcnt vmcnt(8)
    s_mov_b64 exec, -1
    s_mul_i32 s52, s3, 11
    s_sub_u32 s53, s52, 3
    s_and_b32 s52, s53, 15
    s_mul_i32 s52, s52, 1152
    s_lshr_b32 s53, s53, 4
    s_lshl_b32 s53, s53, 2
    s_add_u32 s52, s52, s53
    v_add_u32 v59, s52, v58
    s_mov_b64 exec, s[64:65]
    ds_write_b32 v59, v40 offset:0
    s_mov_b64 exec, s[66:67]
    ds_write_b32 v59, v41 offset:8
    s_mov_b64 exec, s[68:69]
    ds_write_b32 v59, v42 offset:16
    s_mov_b64 exec, s[72:73]
    ds_write_b32 v59, v43 offset:24
L_wo_11:
    s_mov_b64 exec, -1
    s_mov_b64 exec, -1
    s_waitcnt vmcnt(6)
    buffer_load_dwordx4 v[176:179], v3, s[8:11], s62 offen offset:0 nt
    s_mov_b64 exec, -1
    s_waitcnt vmcnt(6)
    buffer_load_dwordx4 v[180:183], v3, s[8:11], s62 offen offset:1024 nt
    s_mov_b64 exec, -1
    s_waitcnt vmcnt(6)
    buffer_load_dwordx4 v[184:187], v3, s[8:11], s62 offen offset:2048 nt
    s_mov_b64 exec, -1
    s_waitcnt vmcnt(6)
    buffer_load_dwordx4 v[188:191], v3, s[8:11], s62 offen offset:3072 nt
    s_waitcnt vmcnt(8)
    s_mov_b64 exec, -1
    s_mul_i32 s52, s3, 11
    s_sub_u32 s53, s52, 2
    s_and_b32 s52, s53, 15
    s_mul_i32 s52, s52, 1152
    s_lshr_b32 s53, s53, 4
    s_lshl_b32 s53, s53, 2
    s_add_u32 s52, s52, s53
    v_add_u32 v59, s52, v58
    s_mov_b64 exec, s[64:65]
    ds_write_b32 v59, v44 offset:0
    s_mov_b64 exec, s[66:67]
    ds_write_b32 v59, v45 offset:8
    s_mov_b64 exec, s[68:69]
    ds_write_b32 v59, v46 offset:16
    s_mov_b64 exec, s[72:73]
    ds_write_b32 v59, v47 offset:24
L_wo_12:
    s_mov_b64 exec, -1
    s_waitcnt vmcnt(5)
    s_mov_b64 exec, -1
    s_cmp_eq_u32 s3, 3
    s_cbranch_scc1 L_wo_13
    s_mul_i32 s52, s3, 11
    s_sub_u32 s53, s52, 1
    s_and_b32 s52, s53, 15
    s_mul_i32 s52, s52, 1152
    s_lshr_b32 s53, s53, 4
    s_lshl_b32 s53, s53, 2
    s_add_u32 s52, s52, s53
    v_add_u32 v59, s52, v58
    s_mov_b64 exec, s[64:65]
    ds_write_b32 v59, v48 offset:0
    s_mov_b64 exec, s[66:67]
    ds_write_b32 v59, v49 offset:8
    s_mov_b64 exec, s[68:69]
    ds_write_b32 v59, v50 offset:16
    s_mov_b64 exec, s[72:73]
    ds_write_b32 v59, v51 offset:24
L_wo_13:
    s_mov_b64 exec, -1
    s_mov_b64 exec, -1
    v_mov_b32 v12, 6352
L_qflag:
    ds_read_b32 v13, v12
    s_waitcnt lgkmcnt(0)
    v_readfirstlane_b32 s52, v13
    s_cmp_eq_u32 s52, 1
    s_cbranch_scc1 L_qflag_ok
    s_sleep 2
    s_branch L_qflag
L_qflag_ok:
    v_lshlrev_b32 v12, 4, v1
    ds_read_b128 v[20:23], v12 offset:0
    s_branch L_join
L_w0:
    v_lshlrev_b32 v12, 1, v1
    buffer_load_ushort v32, v12, s[40:43], 0 offen offset:0
    buffer_load_ushort v33, v12, s[40:43], 0 offen offset:128
    buffer_load_ushort v34, v12, s[40:43], 0 offen offset:256
    buffer_load_ushort v35, v12, s[40:43], 0 offen offset:384
    buffer_load_ushort v36, v12, s[40:43], 0 offen offset:512
    buffer_load_ushort v37, v12, s[40:43], 0 offen offset:640
    buffer_load_ushort v38, v12, s[40:43], 0 offen offset:768
    buffer_load_ushort v39, v12, s[40:43], 0 offen offset:896
    buffer_load_ushort v40, v12, s[40:43], 0 offen offset:1024
    v_lshrrev_b32 v13, 1, v1
    v_lshlrev_b32 v13, 13, v13
    v_and_b32 v14, 1, v1
    v_lshl_add_u32 v13, v14, 4, v13
    v_add_u32 v13, s92, v13
    s_mov_b32 m0, 6624
    s_mov_b32 s62, 0
    buffer_load_dwordx4 v13, s[20:23], s62 offen  lds
    s_mov_b32 m0, 7648
    s_mov_b32 s62, 262144
    buffer_load_dwordx4 v13, s[20:23], s62 offen  lds
    s_mov_b32 m0, 8672
    s_mov_b32 s62, 524288
    buffer_load_dwordx4 v13, s[20:23], s62 offen  lds
    s_mov_b32 m0, 9696
    s_mov_b32 s62, 786432
    buffer_load_dwordx4 v13, s[20:23], s62 offen  lds
    s_mov_b32 m0, 10720
    s_mov_b32 s62, 1048576
    buffer_load_dwordx4 v13, s[20:23], s62 offen  lds
    s_mov_b32 m0, 11744
    s_mov_b32 s62, 1310720
    buffer_load_dwordx4 v13, s[20:23], s62 offen  lds
    s_mov_b32 m0, 12768
    s_mov_b32 s62, 1572864
    buffer_load_dwordx4 v13, s[20:23], s62 offen  lds
    s_mov_b32 m0, 13792
    s_mov_b32 s62, 1835008
    buffer_load_dwordx4 v13, s[20:23], s62 offen  lds
    s_mov_b32 m0, 14816
    s_mov_b32 s62, 2097152
    buffer_load_dwordx4 v13, s[20:23], s62 offen  lds
    s_mov_b32 m0, 15840
    s_mov_b32 s62, 2359296
    buffer_load_dwordx4 v13, s[20:23], s62 offen  lds
    s_mov_b32 m0, 16864
    s_mov_b32 s62, 2621440
    buffer_load_dwordx4 v13, s[20:23], s62 offen  lds
    s_mov_b32 m0, 17888
    s_mov_b32 s62, 2883584
    buffer_load_dwordx4 v13, s[20:23], s62 offen  lds
    s_mov_b32 m0, 18912
    s_mov_b32 s62, 3145728
    buffer_load_dwordx4 v13, s[20:23], s62 offen  lds
    s_mov_b32 m0, 19936
    s_mov_b32 s62, 3407872
    buffer_load_dwordx4 v13, s[20:23], s62 offen  lds
    s_mov_b32 m0, 20960
    s_mov_b32 s62, 3670016
    buffer_load_dwordx4 v13, s[20:23], s62 offen  lds
    s_mov_b32 m0, 21984
    s_mov_b32 s62, 3932160
    buffer_load_dwordx4 v13, s[20:23], s62 offen  lds
    s_mov_b32 m0, 23008
    s_mov_b32 s62, 4194304
    buffer_load_dwordx4 v13, s[20:23], s62 offen  lds
    s_mov_b32 m0, 24032
    s_mov_b32 s62, 4456448
    buffer_load_dwordx4 v13, s[20:23], s62 offen  lds
    v_mov_b32 v20, -1
    v_mov_b32 v21, -1
    v_mov_b32 v22, -1
    v_mov_b32 v23, -1
    v_lshlrev_b32 v16, 4, v1
    v_lshlrev_b32 v17, 2, v1
    s_add_u32 s52, s96, 0
    buffer_store_dwordx4 v[20:23], v16, s[12:15], s52 offen sc1
    s_mov_b64 exec, 1
    buffer_store_dwordx4 v[20:23], v16, s[12:15], s52 offen offset:1024 sc1
    s_mov_b64 exec, 0x3ffff
    s_mul_i32 s52, s48, 2304
    s_mul_i32 s53, s78, 72
    s_add_u32 s53, s53, s52
    s_add_u32 s53, s53, 327680
    buffer_store_dword v20, v17, s[12:15], s53 offen sc1
    s_mul_i32 s53, s80, 72
    s_add_u32 s53, s53, s52
    s_add_u32 s53, s53, 393216
    buffer_store_dword v20, v17, s[12:15], s53 offen sc1
    s_mul_i32 s52, s48, 1152
    s_mul_i32 s53, s79, 36
    s_add_u32 s53, s53, s52
    s_add_u32 s53, s53, 360448
    s_mov_b64 exec, 0x1ff
    buffer_store_dword v20, v17, s[12:15], s53 offen sc1
    s_add_u32 s52, s92, 425984
    s_mov_b64 exec, 0xff
    buffer_store_dword v20, v17, s[12:15], s52 offen sc1
    s_mov_b64 exec, -1
    s_add_u32 s52, s96, 1048576
    buffer_store_dwordx4 v[20:23], v16, s[12:15], s52 offen sc1
    s_mov_b64 exec, 1
    buffer_store_dwordx4 v[20:23], v16, s[12:15], s52 offen offset:1024 sc1
    s_mov_b64 exec, 0x3ffff
    s_mul_i32 s52, s48, 2304
    s_mul_i32 s53, s78, 72
    s_add_u32 s53, s53, s52
    s_add_u32 s53, s53, 1376256
    buffer_store_dword v20, v17, s[12:15], s53 offen sc1
    s_mul_i32 s53, s80, 72
    s_add_u32 s53, s53, s52
    s_add_u32 s53, s53, 1441792
    buffer_store_dword v20, v17, s[12:15], s53 offen sc1
    s_mul_i32 s52, s48, 1152
    s_mul_i32 s53, s79, 36
    s_add_u32 s53, s53, s52
    s_add_u32 s53, s53, 1409024
    s_mov_b64 exec, 0x1ff
    buffer_store_dword v20, v17, s[12:15], s53 offen sc1
    s_mov_b64 exec, -1
    s_and_b32 s52, s49, 15
    s_cmp_lg_u32 s52, 0
    s_cbranch_scc1 L_z_14
    s_lshl_b32 s52, s95, 8
    s_add_u32 s52, s52, 458752
    v_mov_b32 v24, 0
    buffer_store_dword v24, v17, s[12:15], s52 offen sc1
L_z_14:
    s_waitcnt vmcnt(29)
    v_lshlrev_b32 v32, 16, v32
    v_lshlrev_b32 v33, 16, v33
    v_lshlrev_b32 v34, 16, v34
    v_lshlrev_b32 v35, 16, v35
    v_lshlrev_b32 v36, 16, v36
    v_lshlrev_b32 v37, 16, v37
    v_lshlrev_b32 v38, 16, v38
    v_lshlrev_b32 v39, 16, v39
    v_lshlrev_b32 v40, 16, v40
    s_nop 0
    v_readfirstlane_b32 s52, v32
    s_nop 1
    v_subrev_f32 v42, s52, v32
    v_subrev_f32 v43, s52, v33
    v_subrev_f32 v44, s52, v34
    v_subrev_f32 v45, s52, v35
    v_subrev_f32 v46, s52, v36
    v_subrev_f32 v47, s52, v37
    v_subrev_f32 v48, s52, v38
    v_subrev_f32 v49, s52, v39
    v_subrev_f32 v50, s52, v40
    v_add_f32 v15, v42, v43
    v_mul_f32 v16, v42, v42
    v_add_f32 v15, v15, v44
    v_add_f32 v15, v15, v45
    v_add_f32 v15, v15, v46
    v_add_f32 v15, v15, v47
    v_add_f32 v15, v15, v48
    v_add_f32 v15, v15, v49
    v_add_f32 v15, v15, v50
    v_fmac_f32 v16, v43, v43
    v_fmac_f32 v16, v44, v44
    v_fmac_f32 v16, v45, v45
    v_fmac_f32 v16, v46, v46
    v_fmac_f32 v16, v47, v47
    v_fmac_f32 v16, v48, v48
    v_fmac_f32 v16, v49, v49
    v_fmac_f32 v16, v50, v50
    s_nop 0
    s_nop 0
    v_add_f32_dpp v15, v15, v15 quad_perm:[1,0,3,2] row_mask:0xf bank_mask:0xf
    v_add_f32_dpp v16, v16, v16 quad_perm:[1,0,3,2] row_mask:0xf bank_mask:0xf
    s_nop 0
    v_add_f32_dpp v15, v15, v15 quad_perm:[2,3,0,1] row_mask:0xf bank_mask:0xf
    v_add_f32_dpp v16, v16, v16 quad_perm:[2,3,0,1] row_mask:0xf bank_mask:0xf
    s_nop 0
    v_add_f32_dpp v15, v15, v15 row_half_mirror row_mask:0xf bank_mask:0xf
    v_add_f32_dpp v16, v16, v16 row_half_mirror row_mask:0xf bank_mask:0xf
    s_nop 0
    v_add_f32_dpp v15, v15, v15 row_mirror row_mask:0xf bank_mask:0xf
    v_add_f32_dpp v16, v16, v16 row_mirror row_mask:0xf bank_mask:0xf
    v_mov_b32 v17, v15
    v_mov_b32 v14, v16
    s_nop 0
    v_permlane16_swap_b32 v15, v17
    v_permlane16_swap_b32 v16, v14
    v_add_f32 v15, v15, v17
    v_add_f32 v16, v16, v14
    v_mov_b32 v17, v15
    v_mov_b32 v14, v16
    s_nop 0
    v_permlane32_swap_b32 v15, v17
    v_permlane32_swap_b32 v16, v14
    v_add_f32 v15, v15, v17
    v_add_f32 v16, v16, v14
    v_mul_f32 v17, 0x3ae38e39, v15
    v_add_f32 v18, s52, v17
    v_fma_f32 v16, -v17, v15, v16
    v_mul_f32 v16, 0x3ae38e39, v16
    v_max_f32 v13, 0, v16
    v_cvt_pk_bf16_f32 v13, 0, v13
    v_add_f32 v13, 0x3727c5ac, v13
    v_cvt_pk_bf16_f32 v13, 0, v13
    v_sqrt_f32 v13, v13
    v_cvt_pk_bf16_f32 v18, 0, v18
    v_cvt_pk_bf16_f32 v13, 0, v13
    v_rcp_f32 v19, v13
    v_lshlrev_b32 v30, 1, v1
    v_sub_f32 v32, v32, v18
    v_sub_f32 v33, v33, v18
    v_sub_f32 v34, v34, v18
    v_sub_f32 v35, v35, v18
    v_sub_f32 v36, v36, v18
    v_sub_f32 v37, v37, v18
    v_sub_f32 v38, v38, v18
    v_sub_f32 v39, v39, v18
    v_sub_f32 v40, v40, v18
    v_cvt_pk_bf16_f32 v32, 0, v32
    v_cvt_pk_bf16_f32 v33, 0, v33
    v_cvt_pk_bf16_f32 v34, 0, v34
    v_cvt_pk_bf16_f32 v35, 0, v35
    v_cvt_pk_bf16_f32 v36, 0, v36
    v_cvt_pk_bf16_f32 v37, 0, v37
    v_cvt_pk_bf16_f32 v38, 0, v38
    v_cvt_pk_bf16_f32 v39, 0, v39
    v_cvt_pk_bf16_f32 v40, 0, v40
    v_mul_f32 v42, v32, v19
    v_mul_f32 v43, v33, v19
    v_mul_f32 v44, v34, v19
    v_mul_f32 v45, v35, v19
    v_mul_f32 v46, v36, v19
    v_mul_f32 v47, v37, v19
    v_mul_f32 v48, v38, v19
    v_mul_f32 v49, v39, v19
    v_mul_f32 v50, v40, v19
    v_fma_f32 v32, -v42, v13, v32
    v_fma_f32 v33, -v43, v13, v33
    v_fma_f32 v34, -v44, v13, v34
    v_fma_f32 v35, -v45, v13, v35
    v_fma_f32 v36, -v46, v13, v36
    v_fma_f32 v37, -v47, v13, v37
    v_fma_f32 v38, -v48, v13, v38
    v_fma_f32 v39, -v49, v13, v39
    v_fma_f32 v40, -v50, v13, v40
    v_fmac_f32 v42, v32, v19
    v_fmac_f32 v43, v33, v19
    v_fmac_f32 v44, v34, v19
    v_fmac_f32 v45, v35, v19
    v_fmac_f32 v46, v36, v19
    v_fmac_f32 v47, v37, v19
    v_fmac_f32 v48, v38, v19
    v_fmac_f32 v49, v39, v19
    v_fmac_f32 v50, v40, v19
    v_cvt_pk_bf16_f32 v42, v42, v42
    v_cvt_pk_bf16_f32 v43, v43, v43
    v_cvt_pk_bf16_f32 v44, v44, v44
    v_cvt_pk_bf16_f32 v45, v45, v45
    v_cvt_pk_bf16_f32 v46, v46, v46
    v_cvt_pk_bf16_f32 v47, v47, v47
    v_cvt_pk_bf16_f32 v48, v48, v48
    v_cvt_pk_bf16_f32 v49, v49, v49
    v_cvt_pk_bf16_f32 v50, v50, v50
    ds_write_b16 v30, v42 offset:4160
    ds_write_b16 v30, v43 offset:4288
    ds_write_b16 v30, v44 offset:4416
    ds_write_b16 v30, v45 offset:4544
    ds_write_b16 v30, v46 offset:4672
    ds_write_b16 v30, v47 offset:4800
    ds_write_b16 v30, v48 offset:4928
    ds_write_b16 v30, v49 offset:5056
    ds_write_b16 v30, v50 offset:5184
    v_lshrrev_b32 v5, 4, v1
    v_bfe_u32 v13, v1, 2, 2
    v_lshl_add_u32 v5, v5, 3, v13
    v_mul_u32_u24 v5, 32, v5
    v_and_b32 v13, 3, v1
    v_lshl_add_u32 v5, v13, 3, v5
    v_add_u32 v5, 6624, v5
    v_lshrrev_b32 v6, 4, v1
    v_lshlrev_b32 v6, 4, v6
    s_waitcnt vmcnt(0) lgkmcnt(0)
    ds_read_b128 v[16:19], v6 offset:4160
    ds_read_b64_tr_b16 v[20:21], v5 offset:0
    ds_read_b64_tr_b16 v[22:23], v5 offset:128
    ds_read_b128 v[24:27], v6 offset:4224
    ds_read_b64_tr_b16 v[28:29], v5 offset:1024
    ds_read_b64_tr_b16 v[30:31], v5 offset:1152
    ds_read_b128 v[32:35], v6 offset:4288
    ds_read_b64_tr_b16 v[36:37], v5 offset:2048
    ds_read_b64_tr_b16 v[38:39], v5 offset:2176
    ds_read_b128 v[40:43], v6 offset:4352
    ds_read_b64_tr_b16 v[44:45], v5 offset:3072
    ds_read_b64_tr_b16 v[46:47], v5 offset:3200
    ds_read_b128 v[48:51], v6 offset:4416
    ds_read_b64_tr_b16 v[52:53], v5 offset:4096
    ds_read_b64_tr_b16 v[54:55], v5 offset:4224
    s_waitcnt lgkmcnt(12)
    v_mfma_f32_16x16x32_bf16 v[12:15], v[20:23], v[16:19], 0
    ds_read_b128 v[20:23], v6 offset:4480
    ds_read_b64_tr_b16 v[16:17], v5 offset:5120
    ds_read_b64_tr_b16 v[18:19], v5 offset:5248
    s_waitcnt lgkmcnt(12)
    v_mfma_f32_16x16x32_bf16 v[12:15], v[28:31], v[24:27], v[12:15]
    ds_read_b128 v[28:31], v6 offset:4544
    ds_read_b64_tr_b16 v[24:25], v5 offset:6144
    ds_read_b64_tr_b16 v[26:27], v5 offset:6272
    s_waitcnt lgkmcnt(12)
    v_mfma_f32_16x16x32_bf16 v[12:15], v[36:39], v[32:35], v[12:15]
    ds_read_b128 v[36:39], v6 offset:4608
    ds_read_b64_tr_b16 v[32:33], v5 offset:7168
    ds_read_b64_tr_b16 v[34:35], v5 offset:7296
    s_waitcnt lgkmcnt(12)
    v_mfma_f32_16x16x32_bf16 v[12:15], v[44:47], v[40:43], v[12:15]
    ds_read_b128 v[44:47], v6 offset:4672
    ds_read_b64_tr_b16 v[40:41], v5 offset:8192
    ds_read_b64_tr_b16 v[42:43], v5 offset:8320
    s_waitcnt lgkmcnt(12)
    v_mfma_f32_16x16x32_bf16 v[12:15], v[52:55], v[48:51], v[12:15]
    ds_read_b128 v[52:55], v6 offset:4736
    ds_read_b64_tr_b16 v[48:49], v5 offset:9216
    ds_read_b64_tr_b16 v[50:51], v5 offset:9344
    s_waitcnt lgkmcnt(12)
    v_mfma_f32_16x16x32_bf16 v[12:15], v[16:19], v[20:23], v[12:15]
    ds_read_b128 v[16:19], v6 offset:4800
    ds_read_b64_tr_b16 v[20:21], v5 offset:10240
    ds_read_b64_tr_b16 v[22:23], v5 offset:10368
    s_waitcnt lgkmcnt(12)
    v_mfma_f32_16x16x32_bf16 v[12:15], v[24:27], v[28:31], v[12:15]
    ds_read_b128 v[24:27], v6 offset:4864
    ds_read_b64_tr_b16 v[28:29], v5 offset:11264
    ds_read_b64_tr_b16 v[30:31], v5 offset:11392
    s_waitcnt lgkmcnt(12)
    v_mfma_f32_16x16x32_bf16 v[12:15], v[32:35], v[36:39], v[12:15]
    ds_read_b128 v[32:35], v6 offset:4928
    ds_read_b64_tr_b16 v[36:37], v5 offset:12288
    ds_read_b64_tr_b16 v[38:39], v5 offset:12416
    s_waitcnt lgkmcnt(12)
    v_mfma_f32_16x16x32_bf16 v[12:15], v[40:43], v[44:47], v[12:15]
    ds_read_b128 v[40:43], v6 offset:4992
    ds_read_b64_tr_b16 v[44:45], v5 offset:13312
    ds_read_b64_tr_b16 v[46:47], v5 offset:13440
    s_waitcnt lgkmcnt(12)
    v_mfma_f32_16x16x32_bf16 v[12:15], v[48:51], v[52:55], v[12:15]
    ds_read_b128 v[48:51], v6 offset:5056
    ds_read_b64_tr_b16 v[52:53], v5 offset:14336
    ds_read_b64_tr_b16 v[54:55], v5 offset:14464
    s_waitcnt lgkmcnt(12)
    v_mfma_f32_16x16x32_bf16 v[12:15], v[20:23], v[16:19], v[12:15]
    ds_read_b128 v[20:23], v6 offset:5120
    ds_read_b64_tr_b16 v[16:17], v5 offset:15360
    ds_read_b64_tr_b16 v[18:19], v5 offset:15488
    s_waitcnt lgkmcnt(12)
    v_mfma_f32_16x16x32_bf16 v[12:15], v[28:31], v[24:27], v[12:15]
    ds_read_b128 v[28:31], v6 offset:5184
    ds_read_b64_tr_b16 v[24:25], v5 offset:16384
    ds_read_b64_tr_b16 v[26:27], v5 offset:16512
    s_waitcnt lgkmcnt(12)
    v_mfma_f32_16x16x32_bf16 v[12:15], v[36:39], v[32:35], v[12:15]
    ds_read_b128 v[36:39], v6 offset:5248
    ds_read_b64_tr_b16 v[32:33], v5 offset:17408
    ds_read_b64_tr_b16 v[34:35], v5 offset:17536
    s_waitcnt lgkmcnt(12)
    v_mfma_f32_16x16x32_bf16 v[12:15], v[44:47], v[40:43], v[12:15]
    s_waitcnt lgkmcnt(9)
    v_mfma_f32_16x16x32_bf16 v[12:15], v[52:55], v[48:51], v[12:15]
    s_waitcnt lgkmcnt(6)
    v_mfma_f32_16x16x32_bf16 v[12:15], v[16:19], v[20:23], v[12:15]
    s_waitcnt lgkmcnt(3)
    v_mfma_f32_16x16x32_bf16 v[12:15], v[24:27], v[28:31], v[12:15]
    s_waitcnt lgkmcnt(0)
    v_mfma_f32_16x16x32_bf16 v[12:15], v[32:35], v[36:39], v[12:15]
    v_lshrrev_b32 v16, 1, v1
    s_add_u32 s52, s92, 442368
    s_nop 5
    v_cvt_pk_bf16_f32 v18, v12, v13
    v_cvt_pk_bf16_f32 v19, v14, v15
    s_mov_b64 exec, s[70:71]
    buffer_store_dwordx2 v[18:19], v16, s[12:15], s52 offen sc1
    s_mov_b64 exec, -1
    s_waitcnt vmcnt(0)
    s_lshl_b32 s52, s95, 4
    s_getreg_b32 s53, hwreg(HW_REG_XCC_ID)
    s_and_b32 s53, s53, 15
    s_mul_i32 s97, s53, s53
    s_lshl_b32 s97, s97, 8
    s_add_u32 s97, s97, s53
    s_lshl_b32 s97, s97, 8
    s_add_u32 s97, s97, 1
    s_atomic_add s97, s[98:99], s52
    v_mul_u32_u24 v12, 6, v0
    buffer_load_ushort v8, v12, s[40:43], 0 offen offset:0
    buffer_load_ushort v9, v12, s[40:43], 0 offen offset:2
    buffer_load_ushort v10, v12, s[40:43], 0 offen offset:4
    s_add_u32 s62, s90, 638976
    s_waitcnt vmcnt(5)
    buffer_load_dwordx4 v[224:227], v2, s[4:7], s62 offen offset:0 nt
    s_waitcnt vmcnt(5)
    buffer_load_dwordx4 v[228:231], v2, s[4:7], s62 offen offset:1024 nt
    s_waitcnt vmcnt(5)
    buffer_load_dwordx4 v[232:235], v2, s[4:7], s62 offen offset:2048 nt
    s_waitcnt vmcnt(5)
    buffer_load_dwordx4 v[236:239], v2, s[4:7], s62 offen offset:3072 nt
    s_waitcnt vmcnt(5)
    buffer_load_dwordx4 v[240:243], v3, s[8:11], s62 offen offset:0
    s_waitcnt vmcnt(5)
    buffer_load_dwordx4 v[244:247], v3, s[8:11], s62 offen offset:1024
    s_waitcnt vmcnt(5)
    buffer_load_dwordx4 v[248:251], v3, s[8:11], s62 offen offset:2048
    s_waitcnt vmcnt(5)
    buffer_load_dwordx4 v[252:255], v3, s[8:11], s62 offen offset:3072
    s_lshl_b32 s61, s94, 4
    s_mov_b32 s81, 0
    s_atomic_add s81, s[98:99], s61 glc
    s_lshl_b32 s54, s3, 1
    s_add_u32 s62, s90, 1015808
    s_lshl_b32 s55, s54, 13
    s_add_u32 m0, s55, 25056
    s_nop 0
    s_waitcnt vmcnt(5)
    buffer_load_dwordx4 v2, s[4:7], s62 offen offset:0 nt lds
    s_waitcnt vmcnt(5)
    buffer_load_dwordx4 v2, s[4:7], s62 offen offset:1024 nt lds
    s_waitcnt vmcnt(5)
    buffer_load_dwordx4 v2, s[4:7], s62 offen offset:2048 nt lds
    s_waitcnt vmcnt(5)
    buffer_load_dwordx4 v2, s[4:7], s62 offen offset:3072 nt lds
    s_add_u32 m0, m0, 4096
    s_nop 0
    s_waitcnt vmcnt(5)
    buffer_load_dwordx4 v3, s[8:11], s62 offen offset:0 nt lds
    s_waitcnt vmcnt(5)
    buffer_load_dwordx4 v3, s[8:11], s62 offen offset:1024 nt lds
    s_waitcnt vmcnt(5)
    buffer_load_dwordx4 v3, s[8:11], s62 offen offset:2048 nt lds
    s_waitcnt vmcnt(5)
    buffer_load_dwordx4 v3, s[8:11], s62 offen offset:3072 nt lds
    s_mov_b32 s59, 0
L_q1poll:
    s_waitcnt lgkmcnt(0)
    s_and_b32 s81, s81, 0xff
    s_cmp_ge_u32 s81, 16
    s_cbranch_scc1 L_q1ok
    s_sleep 16
    s_mov_b32 s81, 0
    s_atomic_add s81, s[98:99], s61 glc
    s_add_u32 s59, s59, 1
    s_cmp_lt_u32 s59, 65536
    s_cbranch_scc1 L_q1poll
    s_waitcnt lgkmcnt(0)
L_q1ok:
    v_and_b32 v12, 1, v1
    v_lshlrev_b32 v12, 8, v12
    v_lshrrev_b32 v13, 2, v1
    v_lshl_add_u32 v12, v13, 4, v12
    s_add_u32 s52, s93, 442368
    buffer_load_dwordx4 v[20:23], v12, s[12:15], s52 offen sc1
    s_add_u32 s62, s90, 786432
    s_waitcnt vmcnt(5)
    buffer_load_dwordx4 a[0:3], v2, s[4:7], s62 offen offset:0 nt
    s_waitcnt vmcnt(5)
    buffer_load_dwordx4 a[4:7], v2, s[4:7], s62 offen offset:1024 nt
    s_waitcnt vmcnt(5)
    buffer_load_dwordx4 a[8:11], v2, s[4:7], s62 offen offset:2048 nt
    s_waitcnt vmcnt(5)
    buffer_load_dwordx4 a[12:15], v2, s[4:7], s62 offen offset:3072 nt
    s_waitcnt vmcnt(5)
    buffer_load_dwordx4 a[16:19], v3, s[8:11], s62 offen offset:0 nt
    s_waitcnt vmcnt(5)
    buffer_load_dwordx4 a[20:23], v3, s[8:11], s62 offen offset:1024 nt
    s_waitcnt vmcnt(5)
    buffer_load_dwordx4 a[24:27], v3, s[8:11], s62 offen offset:2048 nt
    s_waitcnt vmcnt(5)
    buffer_load_dwordx4 a[28:31], v3, s[8:11], s62 offen offset:3072 nt
    s_waitcnt vmcnt(8)
    v_lshlrev_b32 v12, 4, v1
    ds_write_b128 v12, v[20:23] offset:0
    v_mov_b32 v13, 1
    v_mov_b32 v12, 6352
    s_waitcnt lgkmcnt(0)
    ds_write_b32 v12, v13
    s_add_u32 s62, s90, 802816
    s_waitcnt vmcnt(5)
    buffer_load_dwordx4 a[32:35], v2, s[4:7], s62 offen offset:0 nt
    s_waitcnt vmcnt(5)
    buffer_load_dwordx4 a[36:39], v2, s[4:7], s62 offen offset:1024 nt
    s_waitcnt vmcnt(5)
    buffer_load_dwordx4 a[40:43], v2, s[4:7], s62 offen offset:2048 nt
    s_waitcnt vmcnt(5)
    buffer_load_dwordx4 a[44:47], v2, s[4:7], s62 offen offset:3072 nt
    s_waitcnt vmcnt(5)
    buffer_load_dwordx4 a[48:51], v3, s[8:11], s62 offen offset:0 nt
    s_waitcnt vmcnt(5)
    buffer_load_dwordx4 a[52:55], v3, s[8:11], s62 offen offset:1024 nt
    s_waitcnt vmcnt(5)
    buffer_load_dwordx4 a[56:59], v3, s[8:11], s62 offen offset:2048 nt
    s_waitcnt vmcnt(5)
    buffer_load_dwordx4 a[60:63], v3, s[8:11], s62 offen offset:3072 nt
    s_add_u32 s62, s90, 819200
    s_waitcnt vmcnt(5)
    buffer_load_dwordx4 a[64:67], v2, s[4:7], s62 offen offset:0 nt
    s_waitcnt vmcnt(5)
    buffer_load_dwordx4 a[68:71], v2, s[4:7], s62 offen offset:1024 nt
    s_waitcnt vmcnt(5)
    buffer_load_dwordx4 a[72:75], v2, s[4:7], s62 offen offset:2048 nt
    s_waitcnt vmcnt(5)
    buffer_load_dwordx4 a[76:79], v2, s[4:7], s62 offen offset:3072 nt
    s_waitcnt vmcnt(5)
    buffer_load_dwordx4 a[80:83], v3, s[8:11], s62 offen offset:0 nt
    s_waitcnt vmcnt(5)
    buffer_load_dwordx4 a[84:87], v3, s[8:11], s62 offen offset:1024 nt
    s_waitcnt vmcnt(5)
    buffer_load_dwordx4 a[88:91], v3, s[8:11], s62 offen offset:2048 nt
    s_waitcnt vmcnt(5)
    buffer_load_dwordx4 a[92:95], v3, s[8:11], s62 offen offset:3072 nt
    s_add_u32 s62, s90, 835584
    s_waitcnt vmcnt(5)
    buffer_load_dwordx4 a[96:99], v2, s[4:7], s62 offen offset:0 nt
    s_waitcnt vmcnt(5)
    buffer_load_dwordx4 a[100:103], v2, s[4:7], s62 offen offset:1024 nt
    s_waitcnt vmcnt(5)
    buffer_load_dwordx4 a[104:107], v2, s[4:7], s62 offen offset:2048 nt
    s_waitcnt vmcnt(5)
    buffer_load_dwordx4 a[108:111], v2, s[4:7], s62 offen offset:3072 nt
    s_waitcnt vmcnt(5)
    buffer_load_dwordx4 a[112:115], v3, s[8:11], s62 offen offset:0 nt
    s_waitcnt vmcnt(5)
    buffer_load_dwordx4 a[116:119], v3, s[8:11], s62 offen offset:1024 nt
    s_waitcnt vmcnt(5)
    buffer_load_dwordx4 a[120:123], v3, s[8:11], s62 offen offset:2048 nt
    s_waitcnt vmcnt(5)
    buffer_load_dwordx4 a[124:127], v3, s[8:11], s62 offen offset:3072 nt
    s_add_u32 s62, s90, 851968
    s_waitcnt vmcnt(5)
    buffer_load_dwordx4 a[128:131], v2, s[4:7], s62 offen offset:0 nt
    s_waitcnt vmcnt(5)
    buffer_load_dwordx4 a[132:135], v2, s[4:7], s62 offen offset:1024 nt
    s_waitcnt vmcnt(5)
    buffer_load_dwordx4 a[136:139], v2, s[4:7], s62 offen offset:2048 nt
    s_waitcnt vmcnt(5)
    buffer_load_dwordx4 a[140:143], v2, s[4:7], s62 offen offset:3072 nt
    s_waitcnt vmcnt(5)
    buffer_load_dwordx4 a[144:147], v3, s[8:11], s62 offen offset:0 nt
    s_waitcnt vmcnt(5)
    buffer_load_dwordx4 a[148:151], v3, s[8:11], s62 offen offset:1024 nt
    s_waitcnt vmcnt(5)
    buffer_load_dwordx4 a[152:155], v3, s[8:11], s62 offen offset:2048 nt
    s_waitcnt vmcnt(5)
    buffer_load_dwordx4 a[156:159], v3, s[8:11], s62 offen offset:3072 nt
    s_add_u32 s62, s90, 868352
    s_waitcnt vmcnt(5)
    buffer_load_dwordx4 a[160:163], v2, s[4:7], s62 offen offset:0 nt
    s_waitcnt vmcnt(5)
    buffer_load_dwordx4 a[164:167], v2, s[4:7], s62 offen offset:1024 nt
    s_waitcnt vmcnt(5)
    buffer_load_dwordx4 a[168:171], v2, s[4:7], s62 offen offset:2048 nt
    s_waitcnt vmcnt(5)
    buffer_load_dwordx4 a[172:175], v2, s[4:7], s62 offen offset:3072 nt
    s_waitcnt vmcnt(5)
    buffer_load_dwordx4 a[176:179], v3, s[8:11], s62 offen offset:0 nt
    s_waitcnt vmcnt(5)
    buffer_load_dwordx4 a[180:183], v3, s[8:11], s62 offen offset:1024 nt
    s_waitcnt vmcnt(5)
    buffer_load_dwordx4 a[184:187], v3, s[8:11], s62 offen offset:2048 nt
    s_waitcnt vmcnt(5)
    buffer_load_dwordx4 a[188:191], v3, s[8:11], s62 offen offset:3072 nt
    s_add_u32 s62, s90, 884736
    s_waitcnt vmcnt(5)
    buffer_load_dwordx4 a[192:195], v2, s[4:7], s62 offen offset:0 nt
    s_waitcnt vmcnt(5)
    buffer_load_dwordx4 a[196:199], v2, s[4:7], s62 offen offset:1024 nt
    s_waitcnt vmcnt(5)
    buffer_load_dwordx4 a[200:203], v2, s[4:7], s62 offen offset:2048 nt
    s_waitcnt vmcnt(5)
    buffer_load_dwordx4 a[204:207], v2, s[4:7], s62 offen offset:3072 nt
    s_waitcnt vmcnt(5)
    buffer_load_dwordx4 a[208:211], v3, s[8:11], s62 offen offset:0 nt
    s_waitcnt vmcnt(5)
    buffer_load_dwordx4 a[212:215], v3, s[8:11], s62 offen offset:1024 nt
    s_waitcnt vmcnt(5)
    buffer_load_dwordx4 a[216:219], v3, s[8:11], s62 offen offset:2048 nt
    s_waitcnt vmcnt(5)
    buffer_load_dwordx4 a[220:223], v3, s[8:11], s62 offen offset:3072 nt
    s_add_u32 s62, s90, 901120
    s_waitcnt vmcnt(5)
    buffer_load_dwordx4 a[224:227], v2, s[4:7], s62 offen offset:0 nt
    s_waitcnt vmcnt(5)
    buffer_load_dwordx4 a[228:231], v2, s[4:7], s62 offen offset:1024 nt
    s_waitcnt vmcnt(5)
    buffer_load_dwordx4 a[232:235], v2, s[4:7], s62 offen offset:2048 nt
    s_waitcnt vmcnt(5)
    buffer_load_dwordx4 a[236:239], v2, s[4:7], s62 offen offset:3072 nt
    s_waitcnt vmcnt(5)
    buffer_load_dwordx4 a[240:243], v3, s[8:11], s62 offen offset:0 nt
    s_waitcnt vmcnt(5)
    buffer_load_dwordx4 a[244:247], v3, s[8:11], s62 offen offset:1024 nt
    s_waitcnt vmcnt(5)
    buffer_load_dwordx4 a[248:251], v3, s[8:11], s62 offen offset:2048 nt
    s_waitcnt vmcnt(5)
    buffer_load_dwordx4 a[252:255], v3, s[8:11], s62 offen offset:3072 nt
    s_add_u32 s62, s90, 917504
    s_waitcnt vmcnt(5)
    buffer_load_dwordx4 v[64:67], v2, s[4:7], s62 offen offset:0 nt
    s_waitcnt vmcnt(5)
    buffer_load_dwordx4 v[68:71], v2, s[4:7], s62 offen offset:1024 nt
    s_waitcnt vmcnt(5)
    buffer_load_dwordx4 v[72:75], v2, s[4:7], s62 offen offset:2048 nt
    s_waitcnt vmcnt(5)
    buffer_load_dwordx4 v[76:79], v2, s[4:7], s62 offen offset:3072 nt
    s_waitcnt vmcnt(5)
    buffer_load_dwordx4 v[80:83], v3, s[8:11], s62 offen offset:0 nt
    s_waitcnt vmcnt(5)
    buffer_load_dwordx4 v[84:87], v3, s[8:11], s62 offen offset:1024 nt
    s_waitcnt vmcnt(5)
    buffer_load_dwordx4 v[88:91], v3, s[8:11], s62 offen offset:2048 nt
    s_waitcnt vmcnt(5)
    buffer_load_dwordx4 v[92:95], v3, s[8:11], s62 offen offset:3072 nt
    s_add_u32 s62, s90, 933888
    s_waitcnt vmcnt(5)
    buffer_load_dwordx4 v[96:99], v2, s[4:7], s62 offen offset:0 nt
    s_waitcnt vmcnt(5)
    buffer_load_dwordx4 v[100:103], v2, s[4:7], s62 offen offset:1024 nt
    s_waitcnt vmcnt(5)
    buffer_load_dwordx4 v[104:107], v2, s[4:7], s62 offen offset:2048 nt
    s_waitcnt vmcnt(5)
    buffer_load_dwordx4 v[108:111], v2, s[4:7], s62 offen offset:3072 nt
    s_waitcnt vmcnt(5)
    buffer_load_dwordx4 v[112:115], v3, s[8:11], s62 offen offset:0 nt
    s_waitcnt vmcnt(5)
    buffer_load_dwordx4 v[116:119], v3, s[8:11], s62 offen offset:1024 nt
    s_waitcnt vmcnt(5)
    buffer_load_dwordx4 v[120:123], v3, s[8:11], s62 offen offset:2048 nt
    s_waitcnt vmcnt(5)
    buffer_load_dwordx4 v[124:127], v3, s[8:11], s62 offen offset:3072 nt
    s_add_u32 s62, s90, 950272
    s_waitcnt vmcnt(5)
    buffer_load_dwordx4 v[128:131], v2, s[4:7], s62 offen offset:0 nt
    s_waitcnt vmcnt(5)
    buffer_load_dwordx4 v[132:135], v2, s[4:7], s62 offen offset:1024 nt
    s_waitcnt vmcnt(5)
    buffer_load_dwordx4 v[136:139], v2, s[4:7], s62 offen offset:2048 nt
    s_waitcnt vmcnt(5)
    buffer_load_dwordx4 v[140:143], v2, s[4:7], s62 offen offset:3072 nt
    s_waitcnt vmcnt(5)
    buffer_load_dwordx4 v[144:147], v3, s[8:11], s62 offen offset:0 nt
    s_waitcnt vmcnt(5)
    buffer_load_dwordx4 v[148:151], v3, s[8:11], s62 offen offset:1024 nt
    s_waitcnt vmcnt(5)
    buffer_load_dwordx4 v[152:155], v3, s[8:11], s62 offen offset:2048 nt
    s_waitcnt vmcnt(5)
    buffer_load_dwordx4 v[156:159], v3, s[8:11], s62 offen offset:3072 nt
    v_and_b32 v12, 15, v1
    v_lshlrev_b32 v12, 4, v12
    buffer_load_dword v13, v12, s[16:19], 0 offen sc1
    s_add_u32 s62, s90, 966656
    s_waitcnt vmcnt(5)
    buffer_load_dwordx4 v[160:163], v2, s[4:7], s62 offen offset:0 nt
    s_waitcnt vmcnt(5)
    buffer_load_dwordx4 v[164:167], v2, s[4:7], s62 offen offset:1024 nt
    s_waitcnt vmcnt(5)
    buffer_load_dwordx4 v[168:171], v2, s[4:7], s62 offen offset:2048 nt
    s_waitcnt vmcnt(5)
    buffer_load_dwordx4 v[172:175], v2, s[4:7], s62 offen offset:3072 nt
    s_waitcnt vmcnt(5)
    buffer_load_dwordx4 v[176:179], v3, s[8:11], s62 offen offset:0 nt
    s_waitcnt vmcnt(5)
    buffer_load_dwordx4 v[180:183], v3, s[8:11], s62 offen offset:1024 nt
    s_waitcnt vmcnt(5)
    buffer_load_dwordx4 v[184:187], v3, s[8:11], s62 offen offset:2048 nt
    s_waitcnt vmcnt(5)
    buffer_load_dwordx4 v[188:191], v3, s[8:11], s62 offen offset:3072 nt
    s_mov_b32 s59, 0
    s_waitcnt vmcnt(8)
L_clr:
    v_and_b32 v14, 0xff, v13
    v_cmp_gt_u32 vcc, 16, v14
    s_cbranch_vccz L_clr_ok
    s_sleep 16
    buffer_load_dword v13, v12, s[16:19], 0 offen sc1
    s_waitcnt vmcnt(0)
    s_add_u32 s59, s59, 1
    s_cmp_lt_u32 s59, 65536
    s_cbranch_scc1 L_clr
L_clr_ok:
    s_lshl_b32 s53, s48, 1
    s_add_u32 s54, s53, 1
    v_readlane_b32 s53, v13, s53
    v_readlane_b32 s54, v13, s54
    s_lshl_b32 s52, s97, 4
    s_xor_b32 s53, s53, s52
    s_xor_b32 s54, s54, s52
    s_or_b32 s53, s53, s54
    s_cmp_eq_u32 s53, 0
    s_cselect_b32 s52, 1, 0
    v_mov_b32 v13, s52
    v_mov_b32 v12, 6352
    ds_write_b32 v12, v13 offset:4
L_join:
    v_lshlrev_b32 v8, 16, v8
    v_lshlrev_b32 v9, 16, v9
    v_lshlrev_b32 v10, 16, v10
    s_mul_i32 s52, s48, 2304
    s_lshl_b32 s54, s3, 5
    s_add_u32 s52, s52, s54
    s_mul_i32 s84, s78, 72
    s_add_u32 s84, s84, s52
    s_add_u32 s84, s84, 327680
    s_mul_i32 s86, s80, 72
    s_add_u32 s86, s86, s52
    s_add_u32 s86, s86, 393216
    s_mul_i32 s91, s48, 1152
    s_add_u32 s91, s91, 360448
    s_mul_i32 s85, s79, 36
    s_add_u32 s85, s85, s91
    s_lshl_b32 s54, s3, 4
    s_add_u32 s85, s85, s54
    s_lshl_b32 s87, s48, 5
    s_lshr_b32 s53, s3, 1
    s_lshl_b32 s53, s53, 4
    s_add_u32 s87, s87, s53
    s_mul_i32 s87, s87, 1152
    s_mov_b32 s69, 41
    s_mov_b32 s65, 448
    s_mov_b32 s66, 671744
    s_mov_b32 s67, 1
    s_mov_b32 s57, 2
    s_mov_b32 s88, 2
    s_mov_b32 s60, 0
    s_add_u32 s52, s90, 1032192
    v_writelane_b32 v0, s52, 0
    s_cmp_eq_u32 s3, 0
    s_cselect_b32 s101, 1, 0
    s_add_u32 s58, s90, 983040
    s_add_u32 s89, s90, 622592
    s_mov_b32 s68, 4294950912
    s_mov_b32 s75, s101
    s_mov_b32 s56, 2
    v_mov_b32 v12, 0xff167699
    v_mul_f32 v13, s51, v12
    v_mov_b32 v14, 0
    v_mov_b32 v16, 0
    v_mov_b32 v17, 0
    v_mov_b32 v18, 0
    v_mov_b32 v19, 0
    v_mov_b32 v40, 0
    v_mov_b32 v41, 0
    v_mov_b32 v42, 0
    v_mov_b32 v43, 0
    v_mov_b32 v44, 0
    v_mov_b32 v45, 0
    v_mov_b32 v46, 0
    v_mov_b32 v47, 0
    s_waitcnt lgkmcnt(0)
L_layer:
    v_mfma_f32_16x16x32_bf16 v[24:27], v[192:195], v[20:23], 0
    v_mfma_f32_16x16x32_bf16 v[28:31], v[196:199], v[20:23], 0
    v_mfma_f32_16x16x32_bf16 v[32:35], v[200:203], v[20:23], 0
    v_mfma_f32_16x16x32_bf16 v[36:39], v[204:207], v[20:23], 0
    s_mov_b32 s62, s89
    s_add_u32 s89, s89, s68
    s_add_u32 s88, s88, 1
    buffer_load_dwordx4 v[192:195], v2, s[4:7], s62 offen offset:0 nt
    buffer_load_dwordx4 v[196:199], v2, s[4:7], s62 offen offset:1024 nt
    buffer_load_dwordx4 v[200:203], v2, s[4:7], s62 offen offset:2048 nt
    buffer_load_dwordx4 v[204:207], v2, s[4:7], s62 offen offset:3072 nt
    v_add_f32_dpp v26, v27, v26 row_ror:12 row_mask:0xf bank_mask:0xf
    v_add_f32_dpp v24, v25, v24 row_ror:12 row_mask:0xf bank_mask:0xf
    v_add_f32_dpp v31, v28, v31 row_ror:12 row_mask:0xf bank_mask:0xf
    v_add_f32_dpp v29, v30, v29 row_ror:12 row_mask:0xf bank_mask:0xf
    v_add_f32_dpp v32, v33, v32 row_ror:12 row_mask:0xf bank_mask:0xf
    v_add_f32_dpp v34, v35, v34 row_ror:12 row_mask:0xf bank_mask:0xf
    v_add_f32_dpp v37, v38, v37 row_ror:12 row_mask:0xf bank_mask:0xf
    v_add_f32_dpp v39, v36, v39 row_ror:12 row_mask:0xf bank_mask:0xf
    v_add_f32_dpp v15, v26, v24 row_ror:8 row_mask:0xf bank_mask:0x1
    v_add_f32_dpp v15, v31, v29 row_ror:8 row_mask:0xf bank_mask:0x2
    v_add_f32_dpp v15, v32, v34 row_ror:8 row_mask:0xf bank_mask:0x4
    v_add_f32_dpp v15, v37, v39 row_ror:8 row_mask:0xf bank_mask:0x8
    v_cvt_pk_bf16_f32 v15, 0, v15
    v_mul_f32 v15, 0x3db504f3, v15
    v_cvt_pk_bf16_f32 v15, 0, v15
    v_cmp_gt_f32 vcc, v15, v12
    s_cbranch_vccnz L_resc_15
L_back_16:
    v_fma_f32 v15, v15, s51, -v13
    v_exp_f32 v15, v15
    s_nop 0
    v_add_f32 v14, v14, v15
    v_cvt_pk_bf16_f32 v15, v15, v15
    s_nop 1
    v_and_b32_dpp v40, v15, v4 quad_perm:[0,1,2,3] row_mask:0xf bank_mask:0x1
    v_and_b32_dpp v41, v15, v4 row_ror:4 row_mask:0xf bank_mask:0x2
    v_and_b32_dpp v42, v15, v4 row_ror:8 row_mask:0xf bank_mask:0x4
    v_and_b32_dpp v43, v15, v4 row_ror:12 row_mask:0xf bank_mask:0x8
    v_and_b32_dpp v44, v15, v4 row_ror:12 row_mask:0xf bank_mask:0x1
    v_and_b32_dpp v45, v15, v4 quad_perm:[0,1,2,3] row_mask:0xf bank_mask:0x2
    v_mfma_f32_16x16x32_bf16 v[16:19], v[208:211], v[40:43], v[16:19]
    v_and_b32_dpp v46, v15, v4 row_ror:4 row_mask:0xf bank_mask:0x4
    v_and_b32_dpp v47, v15, v4 row_ror:8 row_mask:0xf bank_mask:0x8
    v_and_b32_dpp v40, v15, v4 row_ror:8 row_mask:0xf bank_mask:0x1
    v_and_b32_dpp v41, v15, v4 row_ror:12 row_mask:0xf bank_mask:0x2
    v_mfma_f32_16x16x32_bf16 v[16:19], v[212:215], v[44:47], v[16:19]
    v_and_b32_dpp v42, v15, v4 quad_perm:[0,1,2,3] row_mask:0xf bank_mask:0x4
    v_and_b32_dpp v43, v15, v4 row_ror:4 row_mask:0xf bank_mask:0x8
    v_and_b32_dpp v44, v15, v4 row_ror:4 row_mask:0xf bank_mask:0x1
    v_and_b32_dpp v45, v15, v4 row_ror:8 row_mask:0xf bank_mask:0x2
    v_mfma_f32_16x16x32_bf16 v[16:19], v[216:219], v[40:43], v[16:19]
    v_and_b32_dpp v46, v15, v4 row_ror:12 row_mask:0xf bank_mask:0x4
    v_and_b32_dpp v47, v15, v4 quad_perm:[0,1,2,3] row_mask:0xf bank_mask:0x8
    s_nop 1
    v_mfma_f32_16x16x32_bf16 v[16:19], v[220:223], v[44:47], v[16:19]
    s_cmp_lg_u32 s67, 1
    s_cbranch_scc1 L_rb_17
    buffer_load_dwordx4 v[208:211], v3, s[8:11], s62 offen offset:0
    buffer_load_dwordx4 v[212:215], v3, s[8:11], s62 offen offset:1024
    buffer_load_dwordx4 v[216:219], v3, s[8:11], s62 offen offset:2048
    buffer_load_dwordx4 v[220:223], v3, s[8:11], s62 offen offset:3072
L_re_18:
    v_mfma_f32_16x16x32_bf16 v[24:27], v[224:227], v[20:23], 0
    v_mfma_f32_16x16x32_bf16 v[28:31], v[228:231], v[20:23], 0
    v_mfma_f32_16x16x32_bf16 v[32:35], v[232:235], v[20:23], 0
    v_mfma_f32_16x16x32_bf16 v[36:39], v[236:239], v[20:23], 0
    s_mov_b32 s62, s89
    s_add_u32 s89, s89, s68
    s_add_u32 s88, s88, 1
    buffer_load_dwordx4 v[224:227], v2, s[4:7], s62 offen offset:0 nt
    buffer_load_dwordx4 v[228:231], v2, s[4:7], s62 offen offset:1024 nt
    buffer_load_dwordx4 v[232:235], v2, s[4:7], s62 offen offset:2048 nt
    buffer_load_dwordx4 v[236:239], v2, s[4:7], s62 offen offset:3072 nt
    v_add_f32_dpp v26, v27, v26 row_ror:12 row_mask:0xf bank_mask:0xf
    v_add_f32_dpp v24, v25, v24 row_ror:12 row_mask:0xf bank_mask:0xf
    v_add_f32_dpp v31, v28, v31 row_ror:12 row_mask:0xf bank_mask:0xf
    v_add_f32_dpp v29, v30, v29 row_ror:12 row_mask:0xf bank_mask:0xf
    v_add_f32_dpp v32, v33, v32 row_ror:12 row_mask:0xf bank_mask:0xf
    v_add_f32_dpp v34, v35, v34 row_ror:12 row_mask:0xf bank_mask:0xf
    v_add_f32_dpp v37, v38, v37 row_ror:12 row_mask:0xf bank_mask:0xf
    v_add_f32_dpp v39, v36, v39 row_ror:12 row_mask:0xf bank_mask:0xf
    v_add_f32_dpp v15, v26, v24 row_ror:8 row_mask:0xf bank_mask:0x1
    v_add_f32_dpp v15, v31, v29 row_ror:8 row_mask:0xf bank_mask:0x2
    v_add_f32_dpp v15, v32, v34 row_ror:8 row_mask:0xf bank_mask:0x4
    v_add_f32_dpp v15, v37, v39 row_ror:8 row_mask:0xf bank_mask:0x8
    v_cvt_pk_bf16_f32 v15, 0, v15
    v_mul_f32 v15, 0x3db504f3, v15
    v_cvt_pk_bf16_f32 v15, 0, v15
    v_cmp_gt_f32 vcc, v15, v12
    s_cbranch_vccnz L_resc_19
L_back_20:
    v_fma_f32 v15, v15, s51, -v13
    v_exp_f32 v15, v15
    s_nop 0
    v_add_f32 v14, v14, v15
    v_cvt_pk_bf16_f32 v15, v15, v15
    s_nop 1
    v_and_b32_dpp v40, v15, v4 quad_perm:[0,1,2,3] row_mask:0xf bank_mask:0x1
    v_and_b32_dpp v41, v15, v4 row_ror:4 row_mask:0xf bank_mask:0x2
    v_and_b32_dpp v42, v15, v4 row_ror:8 row_mask:0xf bank_mask:0x4
    v_and_b32_dpp v43, v15, v4 row_ror:12 row_mask:0xf bank_mask:0x8
    v_and_b32_dpp v44, v15, v4 row_ror:12 row_mask:0xf bank_mask:0x1
    v_and_b32_dpp v45, v15, v4 quad_perm:[0,1,2,3] row_mask:0xf bank_mask:0x2
    v_mfma_f32_16x16x32_bf16 v[16:19], v[240:243], v[40:43], v[16:19]
    v_and_b32_dpp v46, v15, v4 row_ror:4 row_mask:0xf bank_mask:0x4
    v_and_b32_dpp v47, v15, v4 row_ror:8 row_mask:0xf bank_mask:0x8
    v_and_b32_dpp v40, v15, v4 row_ror:8 row_mask:0xf bank_mask:0x1
    v_and_b32_dpp v41, v15, v4 row_ror:12 row_mask:0xf bank_mask:0x2
    v_mfma_f32_16x16x32_bf16 v[16:19], v[244:247], v[44:47], v[16:19]
    v_and_b32_dpp v42, v15, v4 quad_perm:[0,1,2,3] row_mask:0xf bank_mask:0x4
    v_and_b32_dpp v43, v15, v4 row_ror:4 row_mask:0xf bank_mask:0x8
    v_and_b32_dpp v44, v15, v4 row_ror:4 row_mask:0xf bank_mask:0x1
    v_and_b32_dpp v45, v15, v4 row_ror:8 row_mask:0xf bank_mask:0x2
    v_mfma_f32_16x16x32_bf16 v[16:19], v[248:251], v[40:43], v[16:19]
    v_and_b32_dpp v46, v15, v4 row_ror:12 row_mask:0xf bank_mask:0x4
    v_and_b32_dpp v47, v15, v4 quad_perm:[0,1,2,3] row_mask:0xf bank_mask:0x8
    s_nop 1
    v_mfma_f32_16x16x32_bf16 v[16:19], v[252:255], v[44:47], v[16:19]
    s_cmp_lg_u32 s67, 1
    s_cbranch_scc1 L_rb_21
    buffer_load_dwordx4 v[240:243], v3, s[8:11], s62 offen offset:0
    buffer_load_dwordx4 v[244:247], v3, s[8:11], s62 offen offset:1024
    buffer_load_dwordx4 v[248:251], v3, s[8:11], s62 offen offset:2048
    buffer_load_dwordx4 v[252:255], v3, s[8:11], s62 offen offset:3072
L_re_22:
    s_lshl_b32 s54, s3, 14
    s_add_u32 s54, s54, 25056
    v_lshlrev_b32 v5, 4, v1
    v_add_u32 v5, s54, v5
    ds_read_b128 v[48:51], v5 offset:0
    ds_read_b128 v[52:55], v5 offset:1024
    ds_read_b128 v[56:59], v5 offset:2048
    ds_read_b128 v[60:63], v5 offset:3072
    s_waitcnt lgkmcnt(0)
    v_mfma_f32_16x16x32_bf16 v[24:27], v[48:51], v[20:23], 0
    v_mfma_f32_16x16x32_bf16 v[28:31], v[52:55], v[20:23], 0
    v_mfma_f32_16x16x32_bf16 v[32:35], v[56:59], v[20:23], 0
    v_mfma_f32_16x16x32_bf16 v[36:39], v[60:63], v[20:23], 0
    ds_read_b128 v[48:51], v5 offset:4096
    ds_read_b128 v[52:55], v5 offset:5120
    ds_read_b128 v[56:59], v5 offset:6144
    ds_read_b128 v[60:63], v5 offset:7168
    s_nop 0
    v_add_f32_dpp v26, v27, v26 row_ror:12 row_mask:0xf bank_mask:0xf
    v_add_f32_dpp v24, v25, v24 row_ror:12 row_mask:0xf bank_mask:0xf
    v_add_f32_dpp v31, v28, v31 row_ror:12 row_mask:0xf bank_mask:0xf
    v_add_f32_dpp v29, v30, v29 row_ror:12 row_mask:0xf bank_mask:0xf
    v_add_f32_dpp v32, v33, v32 row_ror:12 row_mask:0xf bank_mask:0xf
    v_add_f32_dpp v34, v35, v34 row_ror:12 row_mask:0xf bank_mask:0xf
    v_add_f32_dpp v37, v38, v37 row_ror:12 row_mask:0xf bank_mask:0xf
    v_add_f32_dpp v39, v36, v39 row_ror:12 row_mask:0xf bank_mask:0xf
    v_add_f32_dpp v15, v26, v24 row_ror:8 row_mask:0xf bank_mask:0x1
    v_add_f32_dpp v15, v31, v29 row_ror:8 row_mask:0xf bank_mask:0x2
    v_add_f32_dpp v15, v32, v34 row_ror:8 row_mask:0xf bank_mask:0x4
    v_add_f32_dpp v15, v37, v39 row_ror:8 row_mask:0xf bank_mask:0x8
    v_cvt_pk_bf16_f32 v15, 0, v15
    v_mul_f32 v15, 0x3db504f3, v15
    v_cvt_pk_bf16_f32 v15, 0, v15
    v_cmp_gt_f32 vcc, v15, v12
    s_cbranch_vccnz L_resc_24
L_back_25:
    v_fma_f32 v15, v15, s51, -v13
    v_exp_f32 v15, v15
    s_waitcnt lgkmcnt(0)
    v_add_f32 v14, v14, v15
    v_cvt_pk_bf16_f32 v15, v15, v15
    s_nop 1
    v_and_b32_dpp v40, v15, v4 quad_perm:[0,1,2,3] row_mask:0xf bank_mask:0x1
    v_and_b32_dpp v41, v15, v4 row_ror:4 row_mask:0xf bank_mask:0x2
    v_and_b32_dpp v42, v15, v4 row_ror:8 row_mask:0xf bank_mask:0x4
    v_and_b32_dpp v43, v15, v4 row_ror:12 row_mask:0xf bank_mask:0x8
    v_and_b32_dpp v44, v15, v4 row_ror:12 row_mask:0xf bank_mask:0x1
    v_and_b32_dpp v45, v15, v4 quad_perm:[0,1,2,3] row_mask:0xf bank_mask:0x2
    v_mfma_f32_16x16x32_bf16 v[16:19], v[48:51], v[40:43], v[16:19]
    v_and_b32_dpp v46, v15, v4 row_ror:4 row_mask:0xf bank_mask:0x4
    v_and_b32_dpp v47, v15, v4 row_ror:8 row_mask:0xf bank_mask:0x8
    v_and_b32_dpp v40, v15, v4 row_ror:8 row_mask:0xf bank_mask:0x1
    v_and_b32_dpp v41, v15, v4 row_ror:12 row_mask:0xf bank_mask:0x2
    v_mfma_f32_16x16x32_bf16 v[16:19], v[52:55], v[44:47], v[16:19]
    v_and_b32_dpp v42, v15, v4 quad_perm:[0,1,2,3] row_mask:0xf bank_mask:0x4
    v_and_b32_dpp v43, v15, v4 row_ror:4 row_mask:0xf bank_mask:0x8
    v_and_b32_dpp v44, v15, v4 row_ror:4 row_mask:0xf bank_mask:0x1
    v_and_b32_dpp v45, v15, v4 row_ror:8 row_mask:0xf bank_mask:0x2
    v_mfma_f32_16x16x32_bf16 v[16:19], v[56:59], v[40:43], v[16:19]
    v_and_b32_dpp v46, v15, v4 row_ror:12 row_mask:0xf bank_mask:0x4
    v_and_b32_dpp v47, v15, v4 quad_perm:[0,1,2,3] row_mask:0xf bank_mask:0x8
    s_nop 1
    v_mfma_f32_16x16x32_bf16 v[16:19], v[60:63], v[44:47], v[16:19]
    s_cmp_eq_u32 s3, 0
    s_cbranch_scc1 L_lg_23
    v_subrev_u32 v5, 8192, v5
    ds_read_b128 v[48:51], v5 offset:0
    ds_read_b128 v[52:55], v5 offset:1024
    ds_read_b128 v[56:59], v5 offset:2048
    ds_read_b128 v[60:63], v5 offset:3072
    s_waitcnt lgkmcnt(0)
    v_mfma_f32_16x16x32_bf16 v[24:27], v[48:51], v[20:23], 0
    v_mfma_f32_16x16x32_bf16 v[28:31], v[52:55], v[20:23], 0
    v_mfma_f32_16x16x32_bf16 v[32:35], v[56:59], v[20:23], 0
    v_mfma_f32_16x16x32_bf16 v[36:39], v[60:63], v[20:23], 0
    ds_read_b128 v[48:51], v5 offset:4096
    ds_read_b128 v[52:55], v5 offset:5120
    ds_read_b128 v[56:59], v5 offset:6144
    ds_read_b128 v[60:63], v5 offset:7168
    s_nop 0
    v_add_f32_dpp v26, v27, v26 row_ror:12 row_mask:0xf bank_mask:0xf
    v_add_f32_dpp v24, v25, v24 row_ror:12 row_mask:0xf bank_mask:0xf
    v_add_f32_dpp v31, v28, v31 row_ror:12 row_mask:0xf bank_mask:0xf
    v_add_f32_dpp v29, v30, v29 row_ror:12 row_mask:0xf bank_mask:0xf
    v_add_f32_dpp v32, v33, v32 row_ror:12 row_mask:0xf bank_mask:0xf
    v_add_f32_dpp v34, v35, v34 row_ror:12 row_mask:0xf bank_mask:0xf
    v_add_f32_dpp v37, v38, v37 row_ror:12 row_mask:0xf bank_mask:0xf
    v_add_f32_dpp v39, v36, v39 row_ror:12 row_mask:0xf bank_mask:0xf
    v_add_f32_dpp v15, v26, v24 row_ror:8 row_mask:0xf bank_mask:0x1
    v_add_f32_dpp v15, v31, v29 row_ror:8 row_mask:0xf bank_mask:0x2
    v_add_f32_dpp v15, v32, v34 row_ror:8 row_mask:0xf bank_mask:0x4
    v_add_f32_dpp v15, v37, v39 row_ror:8 row_mask:0xf bank_mask:0x8
    v_cvt_pk_bf16_f32 v15, 0, v15
    v_mul_f32 v15, 0x3db504f3, v15
    v_cvt_pk_bf16_f32 v15, 0, v15
    v_cmp_gt_f32 vcc, v15, v12
    s_cbranch_vccnz L_resc_26
L_back_27:
    v_fma_f32 v15, v15, s51, -v13
    v_exp_f32 v15, v15
    s_waitcnt lgkmcnt(0)
    v_add_f32 v14, v14, v15
    v_cvt_pk_bf16_f32 v15, v15, v15
    s_nop 1
    v_and_b32_dpp v40, v15, v4 quad_perm:[0,1,2,3] row_mask:0xf bank_mask:0x1
    v_and_b32_dpp v41, v15, v4 row_ror:4 row_mask:0xf bank_mask:0x2
    v_and_b32_dpp v42, v15, v4 row_ror:8 row_mask:0xf bank_mask:0x4
    v_and_b32_dpp v43, v15, v4 row_ror:12 row_mask:0xf bank_mask:0x8
    v_and_b32_dpp v44, v15, v4 row_ror:12 row_mask:0xf bank_mask:0x1
    v_and_b32_dpp v45, v15, v4 quad_perm:[0,1,2,3] row_mask:0xf bank_mask:0x2
    v_mfma_f32_16x16x32_bf16 v[16:19], v[48:51], v[40:43], v[16:19]
    v_and_b32_dpp v46, v15, v4 row_ror:4 row_mask:0xf bank_mask:0x4
    v_and_b32_dpp v47, v15, v4 row_ror:8 row_mask:0xf bank_mask:0x8
    v_and_b32_dpp v40, v15, v4 row_ror:8 row_mask:0xf bank_mask:0x1
    v_and_b32_dpp v41, v15, v4 row_ror:12 row_mask:0xf bank_mask:0x2
    v_mfma_f32_16x16x32_bf16 v[16:19], v[52:55], v[44:47], v[16:19]
    v_and_b32_dpp v42, v15, v4 quad_perm:[0,1,2,3] row_mask:0xf bank_mask:0x4
    v_and_b32_dpp v43, v15, v4 row_ror:4 row_mask:0xf bank_mask:0x8
    v_and_b32_dpp v44, v15, v4 row_ror:4 row_mask:0xf bank_mask:0x1
    v_and_b32_dpp v45, v15, v4 row_ror:8 row_mask:0xf bank_mask:0x2
    v_mfma_f32_16x16x32_bf16 v[16:19], v[56:59], v[40:43], v[16:19]
    v_and_b32_dpp v46, v15, v4 row_ror:12 row_mask:0xf bank_mask:0x4
    v_and_b32_dpp v47, v15, v4 quad_perm:[0,1,2,3] row_mask:0xf bank_mask:0x8
    s_nop 1
    v_mfma_f32_16x16x32_bf16 v[16:19], v[60:63], v[44:47], v[16:19]
L_lg_23:
    s_waitcnt vmcnt(16)
    s_waitcnt vmcnt(8)
    v_mfma_f32_16x16x32_bf16 v[24:27], v[192:195], v[20:23], 0
    v_mfma_f32_16x16x32_bf16 v[28:31], v[196:199], v[20:23], 0
    v_mfma_f32_16x16x32_bf16 v[32:35], v[200:203], v[20:23], 0
    v_mfma_f32_16x16x32_bf16 v[36:39], v[204:207], v[20:23], 0
    s_nop 4
    v_add_f32_dpp v26, v27, v26 row_ror:12 row_mask:0xf bank_mask:0xf
    v_add_f32_dpp v24, v25, v24 row_ror:12 row_mask:0xf bank_mask:0xf
    v_add_f32_dpp v31, v28, v31 row_ror:12 row_mask:0xf bank_mask:0xf
    v_add_f32_dpp v29, v30, v29 row_ror:12 row_mask:0xf bank_mask:0xf
    v_add_f32_dpp v32, v33, v32 row_ror:12 row_mask:0xf bank_mask:0xf
    v_add_f32_dpp v34, v35, v34 row_ror:12 row_mask:0xf bank_mask:0xf
    v_add_f32_dpp v37, v38, v37 row_ror:12 row_mask:0xf bank_mask:0xf
    v_add_f32_dpp v39, v36, v39 row_ror:12 row_mask:0xf bank_mask:0xf
    v_add_f32_dpp v15, v26, v24 row_ror:8 row_mask:0xf bank_mask:0x1
    v_add_f32_dpp v15, v31, v29 row_ror:8 row_mask:0xf bank_mask:0x2
    v_add_f32_dpp v15, v32, v34 row_ror:8 row_mask:0xf bank_mask:0x4
    v_add_f32_dpp v15, v37, v39 row_ror:8 row_mask:0xf bank_mask:0x8
    v_cvt_pk_bf16_f32 v15, 0, v15
    v_mul_f32 v15, 0x3db504f3, v15
    v_cvt_pk_bf16_f32 v15, 0, v15
    v_cmp_gt_f32 vcc, v15, v12
    s_cbranch_vccnz L_resc_28
L_back_29:
    v_fma_f32 v15, v15, s51, -v13
    v_exp_f32 v15, v15
    s_nop 0
    v_add_f32 v14, v14, v15
    v_cvt_pk_bf16_f32 v15, v15, v15
    s_nop 1
    v_and_b32_dpp v40, v15, v4 quad_perm:[0,1,2,3] row_mask:0xf bank_mask:0x1
    v_and_b32_dpp v41, v15, v4 row_ror:4 row_mask:0xf bank_mask:0x2
    v_and_b32_dpp v42, v15, v4 row_ror:8 row_mask:0xf bank_mask:0x4
    v_and_b32_dpp v43, v15, v4 row_ror:12 row_mask:0xf bank_mask:0x8
    v_and_b32_dpp v44, v15, v4 row_ror:12 row_mask:0xf bank_mask:0x1
    v_and_b32_dpp v45, v15, v4 quad_perm:[0,1,2,3] row_mask:0xf bank_mask:0x2
    v_mfma_f32_16x16x32_bf16 v[16:19], v[208:211], v[40:43], v[16:19]
    v_and_b32_dpp v46, v15, v4 row_ror:4 row_mask:0xf bank_mask:0x4
    v_and_b32_dpp v47, v15, v4 row_ror:8 row_mask:0xf bank_mask:0x8
    v_and_b32_dpp v40, v15, v4 row_ror:8 row_mask:0xf bank_mask:0x1
    v_and_b32_dpp v41, v15, v4 row_ror:12 row_mask:0xf bank_mask:0x2
    v_mfma_f32_16x16x32_bf16 v[16:19], v[212:215], v[44:47], v[16:19]
    v_and_b32_dpp v42, v15, v4 quad_perm:[0,1,2,3] row_mask:0xf bank_mask:0x4
    v_and_b32_dpp v43, v15, v4 row_ror:4 row_mask:0xf bank_mask:0x8
    v_and_b32_dpp v44, v15, v4 row_ror:4 row_mask:0xf bank_mask:0x1
    v_and_b32_dpp v45, v15, v4 row_ror:8 row_mask:0xf bank_mask:0x2
    v_mfma_f32_16x16x32_bf16 v[16:19], v[216:219], v[40:43], v[16:19]
    v_and_b32_dpp v46, v15, v4 row_ror:12 row_mask:0xf bank_mask:0x4
    v_and_b32_dpp v47, v15, v4 quad_perm:[0,1,2,3] row_mask:0xf bank_mask:0x8
    s_nop 1
    v_mfma_f32_16x16x32_bf16 v[16:19], v[220:223], v[44:47], v[16:19]
    s_cmp_lg_u32 s75, 0
    s_cbranch_scc1 L_erp_30
    s_mov_b32 s62, s89
    s_add_u32 s89, s89, s68
    s_add_u32 s88, s88, 1
L_eis_31:
    s_cmp_lg_u32 s67, 1
    s_cbranch_scc1 L_rb_32
    buffer_load_dwordx4 v[192:195], v2, s[4:7], s62 offen offset:0 nt
    buffer_load_dwordx4 v[196:199], v2, s[4:7], s62 offen offset:1024 nt
    buffer_load_dwordx4 v[200:203], v2, s[4:7], s62 offen offset:2048 nt
    buffer_load_dwordx4 v[204:207], v2, s[4:7], s62 offen offset:3072 nt
    buffer_load_dwordx4 v[208:211], v3, s[8:11], s62 offen offset:0
    buffer_load_dwordx4 v[212:215], v3, s[8:11], s62 offen offset:1024
    buffer_load_dwordx4 v[216:219], v3, s[8:11], s62 offen offset:2048
    buffer_load_dwordx4 v[220:223], v3, s[8:11], s62 offen offset:3072
L_re_33:
    v_mfma_f32_16x16x32_bf16 v[24:27], a[0:3], v[20:23], 0
    v_mfma_f32_16x16x32_bf16 v[28:31], a[4:7], v[20:23], 0
    v_mfma_f32_16x16x32_bf16 v[32:35], a[8:11], v[20:23], 0
    v_mfma_f32_16x16x32_bf16 v[36:39], a[12:15], v[20:23], 0
    s_nop 4
    v_add_f32_dpp v26, v27, v26 row_ror:12 row_mask:0xf bank_mask:0xf
    v_add_f32_dpp v24, v25, v24 row_ror:12 row_mask:0xf bank_mask:0xf
    v_add_f32_dpp v31, v28, v31 row_ror:12 row_mask:0xf bank_mask:0xf
    v_add_f32_dpp v29, v30, v29 row_ror:12 row_mask:0xf bank_mask:0xf
    v_add_f32_dpp v32, v33, v32 row_ror:12 row_mask:0xf bank_mask:0xf
    v_add_f32_dpp v34, v35, v34 row_ror:12 row_mask:0xf bank_mask:0xf
    v_add_f32_dpp v37, v38, v37 row_ror:12 row_mask:0xf bank_mask:0xf
    v_add_f32_dpp v39, v36, v39 row_ror:12 row_mask:0xf bank_mask:0xf
    v_add_f32_dpp v15, v26, v24 row_ror:8 row_mask:0xf bank_mask:0x1
    v_add_f32_dpp v15, v31, v29 row_ror:8 row_mask:0xf bank_mask:0x2
    v_add_f32_dpp v15, v32, v34 row_ror:8 row_mask:0xf bank_mask:0x4
    v_add_f32_dpp v15, v37, v39 row_ror:8 row_mask:0xf bank_mask:0x8
    v_cvt_pk_bf16_f32 v15, 0, v15
    v_mul_f32 v15, 0x3db504f3, v15
    v_cvt_pk_bf16_f32 v15, 0, v15
    v_cmp_gt_f32 vcc, v15, v12
    s_cbranch_vccnz L_resc_34
L_back_35:
    v_fma_f32 v15, v15, s51, -v13
    v_exp_f32 v15, v15
    s_nop 0
    v_add_f32 v14, v14, v15
    v_cvt_pk_bf16_f32 v15, v15, v15
    s_nop 1
    v_and_b32_dpp v40, v15, v4 quad_perm:[0,1,2,3] row_mask:0xf bank_mask:0x1
    v_and_b32_dpp v41, v15, v4 row_ror:4 row_mask:0xf bank_mask:0x2
    v_and_b32_dpp v42, v15, v4 row_ror:8 row_mask:0xf bank_mask:0x4
    v_and_b32_dpp v43, v15, v4 row_ror:12 row_mask:0xf bank_mask:0x8
    v_and_b32_dpp v44, v15, v4 row_ror:12 row_mask:0xf bank_mask:0x1
    v_and_b32_dpp v45, v15, v4 quad_perm:[0,1,2,3] row_mask:0xf bank_mask:0x2
    v_mfma_f32_16x16x32_bf16 v[16:19], a[16:19], v[40:43], v[16:19]
    v_and_b32_dpp v46, v15, v4 row_ror:4 row_mask:0xf bank_mask:0x4
    v_and_b32_dpp v47, v15, v4 row_ror:8 row_mask:0xf bank_mask:0x8
    v_and_b32_dpp v40, v15, v4 row_ror:8 row_mask:0xf bank_mask:0x1
    v_and_b32_dpp v41, v15, v4 row_ror:12 row_mask:0xf bank_mask:0x2
    v_mfma_f32_16x16x32_bf16 v[16:19], a[20:23], v[44:47], v[16:19]
    v_and_b32_dpp v42, v15, v4 quad_perm:[0,1,2,3] row_mask:0xf bank_mask:0x4
    v_and_b32_dpp v43, v15, v4 row_ror:4 row_mask:0xf bank_mask:0x8
    v_and_b32_dpp v44, v15, v4 row_ror:4 row_mask:0xf bank_mask:0x1
    v_and_b32_dpp v45, v15, v4 row_ror:8 row_mask:0xf bank_mask:0x2
    v_mfma_f32_16x16x32_bf16 v[16:19], a[24:27], v[40:43], v[16:19]
    v_and_b32_dpp v46, v15, v4 row_ror:12 row_mask:0xf bank_mask:0x4
    v_and_b32_dpp v47, v15, v4 quad_perm:[0,1,2,3] row_mask:0xf bank_mask:0x8
    s_nop 1
    v_mfma_f32_16x16x32_bf16 v[16:19], a[28:31], v[44:47], v[16:19]
    v_mfma_f32_16x16x32_bf16 v[24:27], a[32:35], v[20:23], 0
    v_mfma_f32_16x16x32_bf16 v[28:31], a[36:39], v[20:23], 0
    v_mfma_f32_16x16x32_bf16 v[32:35], a[40:43], v[20:23], 0
    v_mfma_f32_16x16x32_bf16 v[36:39], a[44:47], v[20:23], 0
    s_nop 4
    v_add_f32_dpp v26, v27, v26 row_ror:12 row_mask:0xf bank_mask:0xf
    v_add_f32_dpp v24, v25, v24 row_ror:12 row_mask:0xf bank_mask:0xf
    v_add_f32_dpp v31, v28, v31 row_ror:12 row_mask:0xf bank_mask:0xf
    v_add_f32_dpp v29, v30, v29 row_ror:12 row_mask:0xf bank_mask:0xf
    v_add_f32_dpp v32, v33, v32 row_ror:12 row_mask:0xf bank_mask:0xf
    v_add_f32_dpp v34, v35, v34 row_ror:12 row_mask:0xf bank_mask:0xf
    v_add_f32_dpp v37, v38, v37 row_ror:12 row_mask:0xf bank_mask:0xf
    v_add_f32_dpp v39, v36, v39 row_ror:12 row_mask:0xf bank_mask:0xf
    v_add_f32_dpp v15, v26, v24 row_ror:8 row_mask:0xf bank_mask:0x1
    v_add_f32_dpp v15, v31, v29 row_ror:8 row_mask:0xf bank_mask:0x2
    v_add_f32_dpp v15, v32, v34 row_ror:8 row_mask:0xf bank_mask:0x4
    v_add_f32_dpp v15, v37, v39 row_ror:8 row_mask:0xf bank_mask:0x8
    v_cvt_pk_bf16_f32 v15, 0, v15
    v_mul_f32 v15, 0x3db504f3, v15
    v_cvt_pk_bf16_f32 v15, 0, v15
    v_cmp_gt_f32 vcc, v15, v12
    s_cbranch_vccnz L_resc_36
L_back_37:
    v_fma_f32 v15, v15, s51, -v13
    v_exp_f32 v15, v15
    s_nop 0
    v_add_f32 v14, v14, v15
    v_cvt_pk_bf16_f32 v15, v15, v15
    s_nop 1
    v_and_b32_dpp v40, v15, v4 quad_perm:[0,1,2,3] row_mask:0xf bank_mask:0x1
    v_and_b32_dpp v41, v15, v4 row_ror:4 row_mask:0xf bank_mask:0x2
    v_and_b32_dpp v42, v15, v4 row_ror:8 row_mask:0xf bank_mask:0x4
    v_and_b32_dpp v43, v15, v4 row_ror:12 row_mask:0xf bank_mask:0x8
    v_and_b32_dpp v44, v15, v4 row_ror:12 row_mask:0xf bank_mask:0x1
    v_and_b32_dpp v45, v15, v4 quad_perm:[0,1,2,3] row_mask:0xf bank_mask:0x2
    v_mfma_f32_16x16x32_bf16 v[16:19], a[48:51], v[40:43], v[16:19]
    v_and_b32_dpp v46, v15, v4 row_ror:4 row_mask:0xf bank_mask:0x4
    v_and_b32_dpp v47, v15, v4 row_ror:8 row_mask:0xf bank_mask:0x8
    v_and_b32_dpp v40, v15, v4 row_ror:8 row_mask:0xf bank_mask:0x1
    v_and_b32_dpp v41, v15, v4 row_ror:12 row_mask:0xf bank_mask:0x2
    v_mfma_f32_16x16x32_bf16 v[16:19], a[52:55], v[44:47], v[16:19]
    v_and_b32_dpp v42, v15, v4 quad_perm:[0,1,2,3] row_mask:0xf bank_mask:0x4
    v_and_b32_dpp v43, v15, v4 row_ror:4 row_mask:0xf bank_mask:0x8
    v_and_b32_dpp v44, v15, v4 row_ror:4 row_mask:0xf bank_mask:0x1
    v_and_b32_dpp v45, v15, v4 row_ror:8 row_mask:0xf bank_mask:0x2
    v_mfma_f32_16x16x32_bf16 v[16:19], a[56:59], v[40:43], v[16:19]
    v_and_b32_dpp v46, v15, v4 row_ror:12 row_mask:0xf bank_mask:0x4
    v_and_b32_dpp v47, v15, v4 quad_perm:[0,1,2,3] row_mask:0xf bank_mask:0x8
    s_nop 1
    v_mfma_f32_16x16x32_bf16 v[16:19], a[60:63], v[44:47], v[16:19]
    s_waitcnt vmcnt(8)
    v_mfma_f32_16x16x32_bf16 v[24:27], v[224:227], v[20:23], 0
    v_mfma_f32_16x16x32_bf16 v[28:31], v[228:231], v[20:23], 0
    v_mfma_f32_16x16x32_bf16 v[32:35], v[232:235], v[20:23], 0
    v_mfma_f32_16x16x32_bf16 v[36:39], v[236:239], v[20:23], 0
    s_nop 4
    v_add_f32_dpp v26, v27, v26 row_ror:12 row_mask:0xf bank_mask:0xf
    v_add_f32_dpp v24, v25, v24 row_ror:12 row_mask:0xf bank_mask:0xf
    v_add_f32_dpp v31, v28, v31 row_ror:12 row_mask:0xf bank_mask:0xf
    v_add_f32_dpp v29, v30, v29 row_ror:12 row_mask:0xf bank_mask:0xf
    v_add_f32_dpp v32, v33, v32 row_ror:12 row_mask:0xf bank_mask:0xf
    v_add_f32_dpp v34, v35, v34 row_ror:12 row_mask:0xf bank_mask:0xf
    v_add_f32_dpp v37, v38, v37 row_ror:12 row_mask:0xf bank_mask:0xf
    v_add_f32_dpp v39, v36, v39 row_ror:12 row_mask:0xf bank_mask:0xf
    v_add_f32_dpp v15, v26, v24 row_ror:8 row_mask:0xf bank_mask:0x1
    v_add_f32_dpp v15, v31, v29 row_ror:8 row_mask:0xf bank_mask:0x2
    v_add_f32_dpp v15, v32, v34 row_ror:8 row_mask:0xf bank_mask:0x4
    v_add_f32_dpp v15, v37, v39 row_ror:8 row_mask:0xf bank_mask:0x8
    v_cvt_pk_bf16_f32 v15, 0, v15
    v_mul_f32 v15, 0x3db504f3, v15
    v_cvt_pk_bf16_f32 v15, 0, v15
    v_cmp_gt_f32 vcc, v15, v12
    s_cbranch_vccnz L_resc_38
L_back_39:
    v_fma_f32 v15, v15, s51, -v13
    v_exp_f32 v15, v15
    s_nop 0
    v_add_f32 v14, v14, v15
    v_cvt_pk_bf16_f32 v15, v15, v15
    s_nop 1
    v_and_b32_dpp v40, v15, v4 quad_perm:[0,1,2,3] row_mask:0xf bank_mask:0x1
    v_and_b32_dpp v41, v15, v4 row_ror:4 row_mask:0xf bank_mask:0x2
    v_and_b32_dpp v42, v15, v4 row_ror:8 row_mask:0xf bank_mask:0x4
    v_and_b32_dpp v43, v15, v4 row_ror:12 row_mask:0xf bank_mask:0x8
    v_and_b32_dpp v44, v15, v4 row_ror:12 row_mask:0xf bank_mask:0x1
    v_and_b32_dpp v45, v15, v4 quad_perm:[0,1,2,3] row_mask:0xf bank_mask:0x2
    v_mfma_f32_16x16x32_bf16 v[16:19], v[240:243], v[40:43], v[16:19]
    v_and_b32_dpp v46, v15, v4 row_ror:4 row_mask:0xf bank_mask:0x4
    v_and_b32_dpp v47, v15, v4 row_ror:8 row_mask:0xf bank_mask:0x8
    v_and_b32_dpp v40, v15, v4 row_ror:8 row_mask:0xf bank_mask:0x1
    v_and_b32_dpp v41, v15, v4 row_ror:12 row_mask:0xf bank_mask:0x2
    v_mfma_f32_16x16x32_bf16 v[16:19], v[244:247], v[44:47], v[16:19]
    v_and_b32_dpp v42, v15, v4 quad_perm:[0,1,2,3] row_mask:0xf bank_mask:0x4
    v_and_b32_dpp v43, v15, v4 row_ror:4 row_mask:0xf bank_mask:0x8
    v_and_b32_dpp v44, v15, v4 row_ror:4 row_mask:0xf bank_mask:0x1
    v_and_b32_dpp v45, v15, v4 row_ror:8 row_mask:0xf bank_mask:0x2
    v_mfma_f32_16x16x32_bf16 v[16:19], v[248:251], v[40:43], v[16:19]
    v_and_b32_dpp v46, v15, v4 row_ror:12 row_mask:0xf bank_mask:0x4
    v_and_b32_dpp v47, v15, v4 quad_perm:[0,1,2,3] row_mask:0xf bank_mask:0x8
    s_nop 1
    v_mfma_f32_16x16x32_bf16 v[16:19], v[252:255], v[44:47], v[16:19]
    s_cmp_lg_u32 s75, 0
    s_cbranch_scc1 L_erp_40
    s_mov_b32 s62, s89
    s_add_u32 s89, s89, s68
    s_add_u32 s88, s88, 1
L_eis_41:
    s_cmp_lg_u32 s67, 1
    s_cbranch_scc1 L_rb_42
    buffer_load_dwordx4 v[224:227], v2, s[4:7], s62 offen offset:0 nt
    buffer_load_dwordx4 v[228:231], v2, s[4:7], s62 offen offset:1024 nt
    buffer_load_dwordx4 v[232:235], v2, s[4:7], s62 offen offset:2048 nt
    buffer_load_dwordx4 v[236:239], v2, s[4:7], s62 offen offset:3072 nt
    buffer_load_dwordx4 v[240:243], v3, s[8:11], s62 offen offset:0
    buffer_load_dwordx4 v[244:247], v3, s[8:11], s62 offen offset:1024
    buffer_load_dwordx4 v[248:251], v3, s[8:11], s62 offen offset:2048
    buffer_load_dwordx4 v[252:255], v3, s[8:11], s62 offen offset:3072
L_re_43:
    v_mfma_f32_16x16x32_bf16 v[24:27], a[64:67], v[20:23], 0
    v_mfma_f32_16x16x32_bf16 v[28:31], a[68:71], v[20:23], 0
    v_mfma_f32_16x16x32_bf16 v[32:35], a[72:75], v[20:23], 0
    v_mfma_f32_16x16x32_bf16 v[36:39], a[76:79], v[20:23], 0
    s_nop 4
    v_add_f32_dpp v26, v27, v26 row_ror:12 row_mask:0xf bank_mask:0xf
    v_add_f32_dpp v24, v25, v24 row_ror:12 row_mask:0xf bank_mask:0xf
    v_add_f32_dpp v31, v28, v31 row_ror:12 row_mask:0xf bank_mask:0xf
    v_add_f32_dpp v29, v30, v29 row_ror:12 row_mask:0xf bank_mask:0xf
    v_add_f32_dpp v32, v33, v32 row_ror:12 row_mask:0xf bank_mask:0xf
    v_add_f32_dpp v34, v35, v34 row_ror:12 row_mask:0xf bank_mask:0xf
    v_add_f32_dpp v37, v38, v37 row_ror:12 row_mask:0xf bank_mask:0xf
    v_add_f32_dpp v39, v36, v39 row_ror:12 row_mask:0xf bank_mask:0xf
    v_add_f32_dpp v15, v26, v24 row_ror:8 row_mask:0xf bank_mask:0x1
    v_add_f32_dpp v15, v31, v29 row_ror:8 row_mask:0xf bank_mask:0x2
    v_add_f32_dpp v15, v32, v34 row_ror:8 row_mask:0xf bank_mask:0x4
    v_add_f32_dpp v15, v37, v39 row_ror:8 row_mask:0xf bank_mask:0x8
    v_cvt_pk_bf16_f32 v15, 0, v15
    v_mul_f32 v15, 0x3db504f3, v15
    v_cvt_pk_bf16_f32 v15, 0, v15
    v_cmp_gt_f32 vcc, v15, v12
    s_cbranch_vccnz L_resc_44
L_back_45:
    v_fma_f32 v15, v15, s51, -v13
    v_exp_f32 v15, v15
    s_nop 0
    v_add_f32 v14, v14, v15
    v_cvt_pk_bf16_f32 v15, v15, v15
    s_nop 1
    v_and_b32_dpp v40, v15, v4 quad_perm:[0,1,2,3] row_mask:0xf bank_mask:0x1
    v_and_b32_dpp v41, v15, v4 row_ror:4 row_mask:0xf bank_mask:0x2
    v_and_b32_dpp v42, v15, v4 row_ror:8 row_mask:0xf bank_mask:0x4
    v_and_b32_dpp v43, v15, v4 row_ror:12 row_mask:0xf bank_mask:0x8
    v_and_b32_dpp v44, v15, v4 row_ror:12 row_mask:0xf bank_mask:0x1
    v_and_b32_dpp v45, v15, v4 quad_perm:[0,1,2,3] row_mask:0xf bank_mask:0x2
    v_mfma_f32_16x16x32_bf16 v[16:19], a[80:83], v[40:43], v[16:19]
    v_and_b32_dpp v46, v15, v4 row_ror:4 row_mask:0xf bank_mask:0x4
    v_and_b32_dpp v47, v15, v4 row_ror:8 row_mask:0xf bank_mask:0x8
    v_and_b32_dpp v40, v15, v4 row_ror:8 row_mask:0xf bank_mask:0x1
    v_and_b32_dpp v41, v15, v4 row_ror:12 row_mask:0xf bank_mask:0x2
    v_mfma_f32_16x16x32_bf16 v[16:19], a[84:87], v[44:47], v[16:19]
    v_and_b32_dpp v42, v15, v4 quad_perm:[0,1,2,3] row_mask:0xf bank_mask:0x4
    v_and_b32_dpp v43, v15, v4 row_ror:4 row_mask:0xf bank_mask:0x8
    v_and_b32_dpp v44, v15, v4 row_ror:4 row_mask:0xf bank_mask:0x1
    v_and_b32_dpp v45, v15, v4 row_ror:8 row_mask:0xf bank_mask:0x2
    v_mfma_f32_16x16x32_bf16 v[16:19], a[88:91], v[40:43], v[16:19]
    v_and_b32_dpp v46, v15, v4 row_ror:12 row_mask:0xf bank_mask:0x4
    v_and_b32_dpp v47, v15, v4 quad_perm:[0,1,2,3] row_mask:0xf bank_mask:0x8
    s_nop 1
    v_mfma_f32_16x16x32_bf16 v[16:19], a[92:95], v[44:47], v[16:19]
    s_waitcnt vmcnt(8)
    v_mfma_f32_16x16x32_bf16 v[24:27], v[192:195], v[20:23], 0
    v_mfma_f32_16x16x32_bf16 v[28:31], v[196:199], v[20:23], 0
    v_mfma_f32_16x16x32_bf16 v[32:35], v[200:203], v[20:23], 0
    v_mfma_f32_16x16x32_bf16 v[36:39], v[204:207], v[20:23], 0
    s_nop 4
    v_add_f32_dpp v26, v27, v26 row_ror:12 row_mask:0xf bank_mask:0xf
    v_add_f32_dpp v24, v25, v24 row_ror:12 row_mask:0xf bank_mask:0xf
    v_add_f32_dpp v31, v28, v31 row_ror:12 row_mask:0xf bank_mask:0xf
    v_add_f32_dpp v29, v30, v29 row_ror:12 row_mask:0xf bank_mask:0xf
    v_add_f32_dpp v32, v33, v32 row_ror:12 row_mask:0xf bank_mask:0xf
    v_add_f32_dpp v34, v35, v34 row_ror:12 row_mask:0xf bank_mask:0xf
    v_add_f32_dpp v37, v38, v37 row_ror:12 row_mask:0xf bank_mask:0xf
    v_add_f32_dpp v39, v36, v39 row_ror:12 row_mask:0xf bank_mask:0xf
    v_add_f32_dpp v15, v26, v24 row_ror:8 row_mask:0xf bank_mask:0x1
    v_add_f32_dpp v15, v31, v29 row_ror:8 row_mask:0xf bank_mask:0x2
    v_add_f32_dpp v15, v32, v34 row_ror:8 row_mask:0xf bank_mask:0x4
    v_add_f32_dpp v15, v37, v39 row_ror:8 row_mask:0xf bank_mask:0x8
    v_cvt_pk_bf16_f32 v15, 0, v15
    v_mul_f32 v15, 0x3db504f3, v15
    v_cvt_pk_bf16_f32 v15, 0, v15
    v_cmp_gt_f32 vcc, v15, v12
    s_cbranch_vccnz L_resc_46
L_back_47:
    v_fma_f32 v15, v15, s51, -v13
    v_exp_f32 v15, v15
    s_nop 0
    v_add_f32 v14, v14, v15
    v_cvt_pk_bf16_f32 v15, v15, v15
    s_nop 1
    v_and_b32_dpp v40, v15, v4 quad_perm:[0,1,2,3] row_mask:0xf bank_mask:0x1
    v_and_b32_dpp v41, v15, v4 row_ror:4 row_mask:0xf bank_mask:0x2
    v_and_b32_dpp v42, v15, v4 row_ror:8 row_mask:0xf bank_mask:0x4
    v_and_b32_dpp v43, v15, v4 row_ror:12 row_mask:0xf bank_mask:0x8
    v_and_b32_dpp v44, v15, v4 row_ror:12 row_mask:0xf bank_mask:0x1
    v_and_b32_dpp v45, v15, v4 quad_perm:[0,1,2,3] row_mask:0xf bank_mask:0x2
    v_mfma_f32_16x16x32_bf16 v[16:19], v[208:211], v[40:43], v[16:19]
    v_and_b32_dpp v46, v15, v4 row_ror:4 row_mask:0xf bank_mask:0x4
    v_and_b32_dpp v47, v15, v4 row_ror:8 row_mask:0xf bank_mask:0x8
    v_and_b32_dpp v40, v15, v4 row_ror:8 row_mask:0xf bank_mask:0x1
    v_and_b32_dpp v41, v15, v4 row_ror:12 row_mask:0xf bank_mask:0x2
    v_mfma_f32_16x16x32_bf16 v[16:19], v[212:215], v[44:47], v[16:19]
    v_and_b32_dpp v42, v15, v4 quad_perm:[0,1,2,3] row_mask:0xf bank_mask:0x4
    v_and_b32_dpp v43, v15, v4 row_ror:4 row_mask:0xf bank_mask:0x8
    v_and_b32_dpp v44, v15, v4 row_ror:4 row_mask:0xf bank_mask:0x1
    v_and_b32_dpp v45, v15, v4 row_ror:8 row_mask:0xf bank_mask:0x2
    v_mfma_f32_16x16x32_bf16 v[16:19], v[216:219], v[40:43], v[16:19]
    v_and_b32_dpp v46, v15, v4 row_ror:12 row_mask:0xf bank_mask:0x4
    v_and_b32_dpp v47, v15, v4 quad_perm:[0,1,2,3] row_mask:0xf bank_mask:0x8
    s_nop 1
    v_mfma_f32_16x16x32_bf16 v[16:19], v[220:223], v[44:47], v[16:19]
    s_cmp_lg_u32 s75, 0
    s_cbranch_scc1 L_erp_48
    s_mov_b32 s62, s89
    s_add_u32 s89, s89, s68
    s_add_u32 s88, s88, 1
L_eis_49:
    s_cmp_lg_u32 s67, 1
    s_cbranch_scc1 L_rb_50
    buffer_load_dwordx4 v[192:195], v2, s[4:7], s62 offen offset:0 nt
    buffer_load_dwordx4 v[196:199], v2, s[4:7], s62 offen offset:1024 nt
    buffer_load_dwordx4 v[200:203], v2, s[4:7], s62 offen offset:2048 nt
    buffer_load_dwordx4 v[204:207], v2, s[4:7], s62 offen offset:3072 nt
    buffer_load_dwordx4 v[208:211], v3, s[8:11], s62 offen offset:0
    buffer_load_dwordx4 v[212:215], v3, s[8:11], s62 offen offset:1024
    buffer_load_dwordx4 v[216:219], v3, s[8:11], s62 offen offset:2048
    buffer_load_dwordx4 v[220:223], v3, s[8:11], s62 offen offset:3072
L_re_51:
    v_mfma_f32_16x16x32_bf16 v[24:27], a[96:99], v[20:23], 0
    v_mfma_f32_16x16x32_bf16 v[28:31], a[100:103], v[20:23], 0
    v_mfma_f32_16x16x32_bf16 v[32:35], a[104:107], v[20:23], 0
    v_mfma_f32_16x16x32_bf16 v[36:39], a[108:111], v[20:23], 0
    s_nop 4
    v_add_f32_dpp v26, v27, v26 row_ror:12 row_mask:0xf bank_mask:0xf
    v_add_f32_dpp v24, v25, v24 row_ror:12 row_mask:0xf bank_mask:0xf
    v_add_f32_dpp v31, v28, v31 row_ror:12 row_mask:0xf bank_mask:0xf
    v_add_f32_dpp v29, v30, v29 row_ror:12 row_mask:0xf bank_mask:0xf
    v_add_f32_dpp v32, v33, v32 row_ror:12 row_mask:0xf bank_mask:0xf
    v_add_f32_dpp v34, v35, v34 row_ror:12 row_mask:0xf bank_mask:0xf
    v_add_f32_dpp v37, v38, v37 row_ror:12 row_mask:0xf bank_mask:0xf
    v_add_f32_dpp v39, v36, v39 row_ror:12 row_mask:0xf bank_mask:0xf
    v_add_f32_dpp v15, v26, v24 row_ror:8 row_mask:0xf bank_mask:0x1
    v_add_f32_dpp v15, v31, v29 row_ror:8 row_mask:0xf bank_mask:0x2
    v_add_f32_dpp v15, v32, v34 row_ror:8 row_mask:0xf bank_mask:0x4
    v_add_f32_dpp v15, v37, v39 row_ror:8 row_mask:0xf bank_mask:0x8
    v_cvt_pk_bf16_f32 v15, 0, v15
    v_mul_f32 v15, 0x3db504f3, v15
    v_cvt_pk_bf16_f32 v15, 0, v15
    v_cmp_gt_f32 vcc, v15, v12
    s_cbranch_vccnz L_resc_52
L_back_53:
    v_fma_f32 v15, v15, s51, -v13
    v_exp_f32 v15, v15
    s_nop 0
    v_add_f32 v14, v14, v15
    v_cvt_pk_bf16_f32 v15, v15, v15
    s_nop 1
    v_and_b32_dpp v40, v15, v4 quad_perm:[0,1,2,3] row_mask:0xf bank_mask:0x1
    v_and_b32_dpp v41, v15, v4 row_ror:4 row_mask:0xf bank_mask:0x2
    v_and_b32_dpp v42, v15, v4 row_ror:8 row_mask:0xf bank_mask:0x4
    v_and_b32_dpp v43, v15, v4 row_ror:12 row_mask:0xf bank_mask:0x8
    v_and_b32_dpp v44, v15, v4 row_ror:12 row_mask:0xf bank_mask:0x1
    v_and_b32_dpp v45, v15, v4 quad_perm:[0,1,2,3] row_mask:0xf bank_mask:0x2
    v_mfma_f32_16x16x32_bf16 v[16:19], a[112:115], v[40:43], v[16:19]
    v_and_b32_dpp v46, v15, v4 row_ror:4 row_mask:0xf bank_mask:0x4
    v_and_b32_dpp v47, v15, v4 row_ror:8 row_mask:0xf bank_mask:0x8
    v_and_b32_dpp v40, v15, v4 row_ror:8 row_mask:0xf bank_mask:0x1
    v_and_b32_dpp v41, v15, v4 row_ror:12 row_mask:0xf bank_mask:0x2
    v_mfma_f32_16x16x32_bf16 v[16:19], a[116:119], v[44:47], v[16:19]
    v_and_b32_dpp v42, v15, v4 quad_perm:[0,1,2,3] row_mask:0xf bank_mask:0x4
    v_and_b32_dpp v43, v15, v4 row_ror:4 row_mask:0xf bank_mask:0x8
    v_and_b32_dpp v44, v15, v4 row_ror:4 row_mask:0xf bank_mask:0x1
    v_and_b32_dpp v45, v15, v4 row_ror:8 row_mask:0xf bank_mask:0x2
    v_mfma_f32_16x16x32_bf16 v[16:19], a[120:123], v[40:43], v[16:19]
    v_and_b32_dpp v46, v15, v4 row_ror:12 row_mask:0xf bank_mask:0x4
    v_and_b32_dpp v47, v15, v4 quad_perm:[0,1,2,3] row_mask:0xf bank_mask:0x8
    s_nop 1
    v_mfma_f32_16x16x32_bf16 v[16:19], a[124:127], v[44:47], v[16:19]
    v_mfma_f32_16x16x32_bf16 v[24:27], a[128:131], v[20:23], 0
    v_mfma_f32_16x16x32_bf16 v[28:31], a[132:135], v[20:23], 0
    v_mfma_f32_16x16x32_bf16 v[32:35], a[136:139], v[20:23], 0
    v_mfma_f32_16x16x32_bf16 v[36:39], a[140:143], v[20:23], 0
    s_nop 4
    v_add_f32_dpp v26, v27, v26 row_ror:12 row_mask:0xf bank_mask:0xf
    v_add_f32_dpp v24, v25, v24 row_ror:12 row_mask:0xf bank_mask:0xf
    v_add_f32_dpp v31, v28, v31 row_ror:12 row_mask:0xf bank_mask:0xf
    v_add_f32_dpp v29, v30, v29 row_ror:12 row_mask:0xf bank_mask:0xf
    v_add_f32_dpp v32, v33, v32 row_ror:12 row_mask:0xf bank_mask:0xf
    v_add_f32_dpp v34, v35, v34 row_ror:12 row_mask:0xf bank_mask:0xf
    v_add_f32_dpp v37, v38, v37 row_ror:12 row_mask:0xf bank_mask:0xf
    v_add_f32_dpp v39, v36, v39 row_ror:12 row_mask:0xf bank_mask:0xf
    v_add_f32_dpp v15, v26, v24 row_ror:8 row_mask:0xf bank_mask:0x1
    v_add_f32_dpp v15, v31, v29 row_ror:8 row_mask:0xf bank_mask:0x2
    v_add_f32_dpp v15, v32, v34 row_ror:8 row_mask:0xf bank_mask:0x4
    v_add_f32_dpp v15, v37, v39 row_ror:8 row_mask:0xf bank_mask:0x8
    v_cvt_pk_bf16_f32 v15, 0, v15
    v_mul_f32 v15, 0x3db504f3, v15
    v_cvt_pk_bf16_f32 v15, 0, v15
    v_cmp_gt_f32 vcc, v15, v12
    s_cbranch_vccnz L_resc_54
L_back_55:
    v_fma_f32 v15, v15, s51, -v13
    v_exp_f32 v15, v15
    s_nop 0
    v_add_f32 v14, v14, v15
    v_cvt_pk_bf16_f32 v15, v15, v15
    s_nop 1
    v_and_b32_dpp v40, v15, v4 quad_perm:[0,1,2,3] row_mask:0xf bank_mask:0x1
    v_and_b32_dpp v41, v15, v4 row_ror:4 row_mask:0xf bank_mask:0x2
    v_and_b32_dpp v42, v15, v4 row_ror:8 row_mask:0xf bank_mask:0x4
    v_and_b32_dpp v43, v15, v4 row_ror:12 row_mask:0xf bank_mask:0x8
    v_and_b32_dpp v44, v15, v4 row_ror:12 row_mask:0xf bank_mask:0x1
    v_and_b32_dpp v45, v15, v4 quad_perm:[0,1,2,3] row_mask:0xf bank_mask:0x2
    v_mfma_f32_16x16x32_bf16 v[16:19], a[144:147], v[40:43], v[16:19]
    v_and_b32_dpp v46, v15, v4 row_ror:4 row_mask:0xf bank_mask:0x4
    v_and_b32_dpp v47, v15, v4 row_ror:8 row_mask:0xf bank_mask:0x8
    v_and_b32_dpp v40, v15, v4 row_ror:8 row_mask:0xf bank_mask:0x1
    v_and_b32_dpp v41, v15, v4 row_ror:12 row_mask:0xf bank_mask:0x2
    v_mfma_f32_16x16x32_bf16 v[16:19], a[148:151], v[44:47], v[16:19]
    v_and_b32_dpp v42, v15, v4 quad_perm:[0,1,2,3] row_mask:0xf bank_mask:0x4
    v_and_b32_dpp v43, v15, v4 row_ror:4 row_mask:0xf bank_mask:0x8
    v_and_b32_dpp v44, v15, v4 row_ror:4 row_mask:0xf bank_mask:0x1
    v_and_b32_dpp v45, v15, v4 row_ror:8 row_mask:0xf bank_mask:0x2
    v_mfma_f32_16x16x32_bf16 v[16:19], a[152:155], v[40:43], v[16:19]
    v_and_b32_dpp v46, v15, v4 row_ror:12 row_mask:0xf bank_mask:0x4
    v_and_b32_dpp v47, v15, v4 quad_perm:[0,1,2,3] row_mask:0xf bank_mask:0x8
    s_nop 1
    v_mfma_f32_16x16x32_bf16 v[16:19], a[156:159], v[44:47], v[16:19]
    s_waitcnt vmcnt(8)
    v_mfma_f32_16x16x32_bf16 v[24:27], v[224:227], v[20:23], 0
    v_mfma_f32_16x16x32_bf16 v[28:31], v[228:231], v[20:23], 0
    v_mfma_f32_16x16x32_bf16 v[32:35], v[232:235], v[20:23], 0
    v_mfma_f32_16x16x32_bf16 v[36:39], v[236:239], v[20:23], 0
    s_nop 4
    v_add_f32_dpp v26, v27, v26 row_ror:12 row_mask:0xf bank_mask:0xf
    v_add_f32_dpp v24, v25, v24 row_ror:12 row_mask:0xf bank_mask:0xf
    v_add_f32_dpp v31, v28, v31 row_ror:12 row_mask:0xf bank_mask:0xf
    v_add_f32_dpp v29, v30, v29 row_ror:12 row_mask:0xf bank_mask:0xf
    v_add_f32_dpp v32, v33, v32 row_ror:12 row_mask:0xf bank_mask:0xf
    v_add_f32_dpp v34, v35, v34 row_ror:12 row_mask:0xf bank_mask:0xf
    v_add_f32_dpp v37, v38, v37 row_ror:12 row_mask:0xf bank_mask:0xf
    v_add_f32_dpp v39, v36, v39 row_ror:12 row_mask:0xf bank_mask:0xf
    v_add_f32_dpp v15, v26, v24 row_ror:8 row_mask:0xf bank_mask:0x1
    v_add_f32_dpp v15, v31, v29 row_ror:8 row_mask:0xf bank_mask:0x2
    v_add_f32_dpp v15, v32, v34 row_ror:8 row_mask:0xf bank_mask:0x4
    v_add_f32_dpp v15, v37, v39 row_ror:8 row_mask:0xf bank_mask:0x8
    v_cvt_pk_bf16_f32 v15, 0, v15
    v_mul_f32 v15, 0x3db504f3, v15
    v_cvt_pk_bf16_f32 v15, 0, v15
    v_cmp_gt_f32 vcc, v15, v12
    s_cbranch_vccnz L_resc_56
L_back_57:
    v_fma_f32 v15, v15, s51, -v13
    v_exp_f32 v15, v15
    s_nop 0
    v_add_f32 v14, v14, v15
    v_cvt_pk_bf16_f32 v15, v15, v15
    s_nop 1
    v_and_b32_dpp v40, v15, v4 quad_perm:[0,1,2,3] row_mask:0xf bank_mask:0x1
    v_and_b32_dpp v41, v15, v4 row_ror:4 row_mask:0xf bank_mask:0x2
    v_and_b32_dpp v42, v15, v4 row_ror:8 row_mask:0xf bank_mask:0x4
    v_and_b32_dpp v43, v15, v4 row_ror:12 row_mask:0xf bank_mask:0x8
    v_and_b32_dpp v44, v15, v4 row_ror:12 row_mask:0xf bank_mask:0x1
    v_and_b32_dpp v45, v15, v4 quad_perm:[0,1,2,3] row_mask:0xf bank_mask:0x2
    v_mfma_f32_16x16x32_bf16 v[16:19], v[240:243], v[40:43], v[16:19]
    v_and_b32_dpp v46, v15, v4 row_ror:4 row_mask:0xf bank_mask:0x4
    v_and_b32_dpp v47, v15, v4 row_ror:8 row_mask:0xf bank_mask:0x8
    v_and_b32_dpp v40, v15, v4 row_ror:8 row_mask:0xf bank_mask:0x1
    v_and_b32_dpp v41, v15, v4 row_ror:12 row_mask:0xf bank_mask:0x2
    v_mfma_f32_16x16x32_bf16 v[16:19], v[244:247], v[44:47], v[16:19]
    v_and_b32_dpp v42, v15, v4 quad_perm:[0,1,2,3] row_mask:0xf bank_mask:0x4
    v_and_b32_dpp v43, v15, v4 row_ror:4 row_mask:0xf bank_mask:0x8
    v_and_b32_dpp v44, v15, v4 row_ror:4 row_mask:0xf bank_mask:0x1
    v_and_b32_dpp v45, v15, v4 row_ror:8 row_mask:0xf bank_mask:0x2
    v_mfma_f32_16x16x32_bf16 v[16:19], v[248:251], v[40:43], v[16:19]
    v_and_b32_dpp v46, v15, v4 row_ror:12 row_mask:0xf bank_mask:0x4
    v_and_b32_dpp v47, v15, v4 quad_perm:[0,1,2,3] row_mask:0xf bank_mask:0x8
    s_nop 1
    v_mfma_f32_16x16x32_bf16 v[16:19], v[252:255], v[44:47], v[16:19]
    s_cmp_lg_u32 s75, 0
    s_cbranch_scc1 L_erp_58
    s_mov_b32 s62, s89
    s_add_u32 s89, s89, s68
    s_add_u32 s88, s88, 1
L_eis_59:
    s_cmp_lg_u32 s67, 1
    s_cbranch_scc1 L_rb_60
    buffer_load_dwordx4 v[224:227], v2, s[4:7], s62 offen offset:0 nt
    buffer_load_dwordx4 v[228:231], v2, s[4:7], s62 offen offset:1024 nt
    buffer_load_dwordx4 v[232:235], v2, s[4:7], s62 offen offset:2048 nt
    buffer_load_dwordx4 v[236:239], v2, s[4:7], s62 offen offset:3072 nt
    buffer_load_dwordx4 v[240:243], v3, s[8:11], s62 offen offset:0
    buffer_load_dwordx4 v[244:247], v3, s[8:11], s62 offen offset:1024
    buffer_load_dwordx4 v[248:251], v3, s[8:11], s62 offen offset:2048
    buffer_load_dwordx4 v[252:255], v3, s[8:11], s62 offen offset:3072
L_re_61:
    v_mfma_f32_16x16x32_bf16 v[24:27], a[160:163], v[20:23], 0
    v_mfma_f32_16x16x32_bf16 v[28:31], a[164:167], v[20:23], 0
    v_mfma_f32_16x16x32_bf16 v[32:35], a[168:171], v[20:23], 0
    v_mfma_f32_16x16x32_bf16 v[36:39], a[172:175], v[20:23], 0
    s_nop 4
    v_add_f32_dpp v26, v27, v26 row_ror:12 row_mask:0xf bank_mask:0xf
    v_add_f32_dpp v24, v25, v24 row_ror:12 row_mask:0xf bank_mask:0xf
    v_add_f32_dpp v31, v28, v31 row_ror:12 row_mask:0xf bank_mask:0xf
    v_add_f32_dpp v29, v30, v29 row_ror:12 row_mask:0xf bank_mask:0xf
    v_add_f32_dpp v32, v33, v32 row_ror:12 row_mask:0xf bank_mask:0xf
    v_add_f32_dpp v34, v35, v34 row_ror:12 row_mask:0xf bank_mask:0xf
    v_add_f32_dpp v37, v38, v37 row_ror:12 row_mask:0xf bank_mask:0xf
    v_add_f32_dpp v39, v36, v39 row_ror:12 row_mask:0xf bank_mask:0xf
    v_add_f32_dpp v15, v26, v24 row_ror:8 row_mask:0xf bank_mask:0x1
    v_add_f32_dpp v15, v31, v29 row_ror:8 row_mask:0xf bank_mask:0x2
    v_add_f32_dpp v15, v32, v34 row_ror:8 row_mask:0xf bank_mask:0x4
    v_add_f32_dpp v15, v37, v39 row_ror:8 row_mask:0xf bank_mask:0x8
    v_cvt_pk_bf16_f32 v15, 0, v15
    v_mul_f32 v15, 0x3db504f3, v15
    v_cvt_pk_bf16_f32 v15, 0, v15
    v_cmp_gt_f32 vcc, v15, v12
    s_cbranch_vccnz L_resc_62
L_back_63:
    v_fma_f32 v15, v15, s51, -v13
    v_exp_f32 v15, v15
    s_nop 0
    v_add_f32 v14, v14, v15
    v_cvt_pk_bf16_f32 v15, v15, v15
    s_nop 1
    v_and_b32_dpp v40, v15, v4 quad_perm:[0,1,2,3] row_mask:0xf bank_mask:0x1
    v_and_b32_dpp v41, v15, v4 row_ror:4 row_mask:0xf bank_mask:0x2
    v_and_b32_dpp v42, v15, v4 row_ror:8 row_mask:0xf bank_mask:0x4
    v_and_b32_dpp v43, v15, v4 row_ror:12 row_mask:0xf bank_mask:0x8
    v_and_b32_dpp v44, v15, v4 row_ror:12 row_mask:0xf bank_mask:0x1
    v_and_b32_dpp v45, v15, v4 quad_perm:[0,1,2,3] row_mask:0xf bank_mask:0x2
    v_mfma_f32_16x16x32_bf16 v[16:19], a[176:179], v[40:43], v[16:19]
    v_and_b32_dpp v46, v15, v4 row_ror:4 row_mask:0xf bank_mask:0x4
    v_and_b32_dpp v47, v15, v4 row_ror:8 row_mask:0xf bank_mask:0x8
    v_and_b32_dpp v40, v15, v4 row_ror:8 row_mask:0xf bank_mask:0x1
    v_and_b32_dpp v41, v15, v4 row_ror:12 row_mask:0xf bank_mask:0x2
    v_mfma_f32_16x16x32_bf16 v[16:19], a[180:183], v[44:47], v[16:19]
    v_and_b32_dpp v42, v15, v4 quad_perm:[0,1,2,3] row_mask:0xf bank_mask:0x4
    v_and_b32_dpp v43, v15, v4 row_ror:4 row_mask:0xf bank_mask:0x8
    v_and_b32_dpp v44, v15, v4 row_ror:4 row_mask:0xf bank_mask:0x1
    v_and_b32_dpp v45, v15, v4 row_ror:8 row_mask:0xf bank_mask:0x2
    v_mfma_f32_16x16x32_bf16 v[16:19], a[184:187], v[40:43], v[16:19]
    v_and_b32_dpp v46, v15, v4 row_ror:12 row_mask:0xf bank_mask:0x4
    v_and_b32_dpp v47, v15, v4 quad_perm:[0,1,2,3] row_mask:0xf bank_mask:0x8
    s_nop 1
    v_mfma_f32_16x16x32_bf16 v[16:19], a[188:191], v[44:47], v[16:19]
    s_waitcnt vmcnt(8)
    v_mfma_f32_16x16x32_bf16 v[24:27], v[192:195], v[20:23], 0
    v_mfma_f32_16x16x32_bf16 v[28:31], v[196:199], v[20:23], 0
    v_mfma_f32_16x16x32_bf16 v[32:35], v[200:203], v[20:23], 0
    v_mfma_f32_16x16x32_bf16 v[36:39], v[204:207], v[20:23], 0
    s_nop 4
    v_add_f32_dpp v26, v27, v26 row_ror:12 row_mask:0xf bank_mask:0xf
    v_add_f32_dpp v24, v25, v24 row_ror:12 row_mask:0xf bank_mask:0xf
    v_add_f32_dpp v31, v28, v31 row_ror:12 row_mask:0xf bank_mask:0xf
    v_add_f32_dpp v29, v30, v29 row_ror:12 row_mask:0xf bank_mask:0xf
    v_add_f32_dpp v32, v33, v32 row_ror:12 row_mask:0xf bank_mask:0xf
    v_add_f32_dpp v34, v35, v34 row_ror:12 row_mask:0xf bank_mask:0xf
    v_add_f32_dpp v37, v38, v37 row_ror:12 row_mask:0xf bank_mask:0xf
    v_add_f32_dpp v39, v36, v39 row_ror:12 row_mask:0xf bank_mask:0xf
    v_add_f32_dpp v15, v26, v24 row_ror:8 row_mask:0xf bank_mask:0x1
    v_add_f32_dpp v15, v31, v29 row_ror:8 row_mask:0xf bank_mask:0x2
    v_add_f32_dpp v15, v32, v34 row_ror:8 row_mask:0xf bank_mask:0x4
    v_add_f32_dpp v15, v37, v39 row_ror:8 row_mask:0xf bank_mask:0x8
    v_cvt_pk_bf16_f32 v15, 0, v15
    v_mul_f32 v15, 0x3db504f3, v15
    v_cvt_pk_bf16_f32 v15, 0, v15
    v_cmp_gt_f32 vcc, v15, v12
    s_cbranch_vccnz L_resc_64
L_back_65:
    v_fma_f32 v15, v15, s51, -v13
    v_exp_f32 v15, v15
    s_nop 0
    v_add_f32 v14, v14, v15
    v_cvt_pk_bf16_f32 v15, v15, v15
    s_nop 1
    v_and_b32_dpp v40, v15, v4 quad_perm:[0,1,2,3] row_mask:0xf bank_mask:0x1
    v_and_b32_dpp v41, v15, v4 row_ror:4 row_mask:0xf bank_mask:0x2
    v_and_b32_dpp v42, v15, v4 row_ror:8 row_mask:0xf bank_mask:0x4
    v_and_b32_dpp v43, v15, v4 row_ror:12 row_mask:0xf bank_mask:0x8
    v_and_b32_dpp v44, v15, v4 row_ror:12 row_mask:0xf bank_mask:0x1
    v_and_b32_dpp v45, v15, v4 quad_perm:[0,1,2,3] row_mask:0xf bank_mask:0x2
    v_mfma_f32_16x16x32_bf16 v[16:19], v[208:211], v[40:43], v[16:19]
    v_and_b32_dpp v46, v15, v4 row_ror:4 row_mask:0xf bank_mask:0x4
    v_and_b32_dpp v47, v15, v4 row_ror:8 row_mask:0xf bank_mask:0x8
    v_and_b32_dpp v40, v15, v4 row_ror:8 row_mask:0xf bank_mask:0x1
    v_and_b32_dpp v41, v15, v4 row_ror:12 row_mask:0xf bank_mask:0x2
    v_mfma_f32_16x16x32_bf16 v[16:19], v[212:215], v[44:47], v[16:19]
    v_and_b32_dpp v42, v15, v4 quad_perm:[0,1,2,3] row_mask:0xf bank_mask:0x4
    v_and_b32_dpp v43, v15, v4 row_ror:4 row_mask:0xf bank_mask:0x8
    v_and_b32_dpp v44, v15, v4 row_ror:4 row_mask:0xf bank_mask:0x1
    v_and_b32_dpp v45, v15, v4 row_ror:8 row_mask:0xf bank_mask:0x2
    v_mfma_f32_16x16x32_bf16 v[16:19], v[216:219], v[40:43], v[16:19]
    v_and_b32_dpp v46, v15, v4 row_ror:12 row_mask:0xf bank_mask:0x4
    v_and_b32_dpp v47, v15, v4 quad_perm:[0,1,2,3] row_mask:0xf bank_mask:0x8
    s_nop 1
    v_mfma_f32_16x16x32_bf16 v[16:19], v[220:223], v[44:47], v[16:19]
    s_cmp_lg_u32 s75, 0
    s_cbranch_scc1 L_erp_66
    s_mov_b32 s62, s89
    s_add_u32 s89, s89, s68
    s_add_u32 s88, s88, 1
L_eis_67:
    s_cmp_lg_u32 s67, 1
    s_cbranch_scc1 L_rb_68
    buffer_load_dwordx4 v[192:195], v2, s[4:7], s62 offen offset:0 nt
    buffer_load_dwordx4 v[196:199], v2, s[4:7], s62 offen offset:1024 nt
    buffer_load_dwordx4 v[200:203], v2, s[4:7], s62 offen offset:2048 nt
    buffer_load_dwordx4 v[204:207], v2, s[4:7], s62 offen offset:3072 nt
    buffer_load_dwordx4 v[208:211], v3, s[8:11], s62 offen offset:0
    buffer_load_dwordx4 v[212:215], v3, s[8:11], s62 offen offset:1024
    buffer_load_dwordx4 v[216:219], v3, s[8:11], s62 offen offset:2048
    buffer_load_dwordx4 v[220:223], v3, s[8:11], s62 offen offset:3072
L_re_69:
    v_mfma_f32_16x16x32_bf16 v[24:27], a[192:195], v[20:23], 0
    v_mfma_f32_16x16x32_bf16 v[28:31], a[196:199], v[20:23], 0
    v_mfma_f32_16x16x32_bf16 v[32:35], a[200:203], v[20:23], 0
    v_mfma_f32_16x16x32_bf16 v[36:39], a[204:207], v[20:23], 0
    s_nop 4
    v_add_f32_dpp v26, v27, v26 row_ror:12 row_mask:0xf bank_mask:0xf
    v_add_f32_dpp v24, v25, v24 row_ror:12 row_mask:0xf bank_mask:0xf
    v_add_f32_dpp v31, v28, v31 row_ror:12 row_mask:0xf bank_mask:0xf
    v_add_f32_dpp v29, v30, v29 row_ror:12 row_mask:0xf bank_mask:0xf
    v_add_f32_dpp v32, v33, v32 row_ror:12 row_mask:0xf bank_mask:0xf
    v_add_f32_dpp v34, v35, v34 row_ror:12 row_mask:0xf bank_mask:0xf
    v_add_f32_dpp v37, v38, v37 row_ror:12 row_mask:0xf bank_mask:0xf
    v_add_f32_dpp v39, v36, v39 row_ror:12 row_mask:0xf bank_mask:0xf
    v_add_f32_dpp v15, v26, v24 row_ror:8 row_mask:0xf bank_mask:0x1
    v_add_f32_dpp v15, v31, v29 row_ror:8 row_mask:0xf bank_mask:0x2
    v_add_f32_dpp v15, v32, v34 row_ror:8 row_mask:0xf bank_mask:0x4
    v_add_f32_dpp v15, v37, v39 row_ror:8 row_mask:0xf bank_mask:0x8
    v_cvt_pk_bf16_f32 v15, 0, v15
    v_mul_f32 v15, 0x3db504f3, v15
    v_cvt_pk_bf16_f32 v15, 0, v15
    v_cmp_gt_f32 vcc, v15, v12
    s_cbranch_vccnz L_resc_70
L_back_71:
    v_fma_f32 v15, v15, s51, -v13
    v_exp_f32 v15, v15
    s_nop 0
    v_add_f32 v14, v14, v15
    v_cvt_pk_bf16_f32 v15, v15, v15
    s_nop 1
    v_and_b32_dpp v40, v15, v4 quad_perm:[0,1,2,3] row_mask:0xf bank_mask:0x1
    v_and_b32_dpp v41, v15, v4 row_ror:4 row_mask:0xf bank_mask:0x2
    v_and_b32_dpp v42, v15, v4 row_ror:8 row_mask:0xf bank_mask:0x4
    v_and_b32_dpp v43, v15, v4 row_ror:12 row_mask:0xf bank_mask:0x8
    v_and_b32_dpp v44, v15, v4 row_ror:12 row_mask:0xf bank_mask:0x1
    v_and_b32_dpp v45, v15, v4 quad_perm:[0,1,2,3] row_mask:0xf bank_mask:0x2
    v_mfma_f32_16x16x32_bf16 v[16:19], a[208:211], v[40:43], v[16:19]
    v_and_b32_dpp v46, v15, v4 row_ror:4 row_mask:0xf bank_mask:0x4
    v_and_b32_dpp v47, v15, v4 row_ror:8 row_mask:0xf bank_mask:0x8
    v_and_b32_dpp v40, v15, v4 row_ror:8 row_mask:0xf bank_mask:0x1
    v_and_b32_dpp v41, v15, v4 row_ror:12 row_mask:0xf bank_mask:0x2
    v_mfma_f32_16x16x32_bf16 v[16:19], a[212:215], v[44:47], v[16:19]
    v_and_b32_dpp v42, v15, v4 quad_perm:[0,1,2,3] row_mask:0xf bank_mask:0x4
    v_and_b32_dpp v43, v15, v4 row_ror:4 row_mask:0xf bank_mask:0x8
    v_and_b32_dpp v44, v15, v4 row_ror:4 row_mask:0xf bank_mask:0x1
    v_and_b32_dpp v45, v15, v4 row_ror:8 row_mask:0xf bank_mask:0x2
    v_mfma_f32_16x16x32_bf16 v[16:19], a[216:219], v[40:43], v[16:19]
    v_and_b32_dpp v46, v15, v4 row_ror:12 row_mask:0xf bank_mask:0x4
    v_and_b32_dpp v47, v15, v4 quad_perm:[0,1,2,3] row_mask:0xf bank_mask:0x8
    s_nop 1
    v_mfma_f32_16x16x32_bf16 v[16:19], a[220:223], v[44:47], v[16:19]
    v_mfma_f32_16x16x32_bf16 v[24:27], a[224:227], v[20:23], 0
    v_mfma_f32_16x16x32_bf16 v[28:31], a[228:231], v[20:23], 0
    v_mfma_f32_16x16x32_bf16 v[32:35], a[232:235], v[20:23], 0
    v_mfma_f32_16x16x32_bf16 v[36:39], a[236:239], v[20:23], 0
    s_nop 4
    v_add_f32_dpp v26, v27, v26 row_ror:12 row_mask:0xf bank_mask:0xf
    v_add_f32_dpp v24, v25, v24 row_ror:12 row_mask:0xf bank_mask:0xf
    v_add_f32_dpp v31, v28, v31 row_ror:12 row_mask:0xf bank_mask:0xf
    v_add_f32_dpp v29, v30, v29 row_ror:12 row_mask:0xf bank_mask:0xf
    v_add_f32_dpp v32, v33, v32 row_ror:12 row_mask:0xf bank_mask:0xf
    v_add_f32_dpp v34, v35, v34 row_ror:12 row_mask:0xf bank_mask:0xf
    v_add_f32_dpp v37, v38, v37 row_ror:12 row_mask:0xf bank_mask:0xf
    v_add_f32_dpp v39, v36, v39 row_ror:12 row_mask:0xf bank_mask:0xf
    v_add_f32_dpp v15, v26, v24 row_ror:8 row_mask:0xf bank_mask:0x1
    v_add_f32_dpp v15, v31, v29 row_ror:8 row_mask:0xf bank_mask:0x2
    v_add_f32_dpp v15, v32, v34 row_ror:8 row_mask:0xf bank_mask:0x4
    v_add_f32_dpp v15, v37, v39 row_ror:8 row_mask:0xf bank_mask:0x8
    v_cvt_pk_bf16_f32 v15, 0, v15
    v_mul_f32 v15, 0x3db504f3, v15
    v_cvt_pk_bf16_f32 v15, 0, v15
    v_cmp_gt_f32 vcc, v15, v12
    s_cbranch_vccnz L_resc_72
L_back_73:
    v_fma_f32 v15, v15, s51, -v13
    v_exp_f32 v15, v15
    s_nop 0
    v_add_f32 v14, v14, v15
    v_cvt_pk_bf16_f32 v15, v15, v15
    s_nop 1
    v_and_b32_dpp v40, v15, v4 quad_perm:[0,1,2,3] row_mask:0xf bank_mask:0x1
    v_and_b32_dpp v41, v15, v4 row_ror:4 row_mask:0xf bank_mask:0x2
    v_and_b32_dpp v42, v15, v4 row_ror:8 row_mask:0xf bank_mask:0x4
    v_and_b32_dpp v43, v15, v4 row_ror:12 row_mask:0xf bank_mask:0x8
    v_and_b32_dpp v44, v15, v4 row_ror:12 row_mask:0xf bank_mask:0x1
    v_and_b32_dpp v45, v15, v4 quad_perm:[0,1,2,3] row_mask:0xf bank_mask:0x2
    v_mfma_f32_16x16x32_bf16 v[16:19], a[240:243], v[40:43], v[16:19]
    v_and_b32_dpp v46, v15, v4 row_ror:4 row_mask:0xf bank_mask:0x4
    v_and_b32_dpp v47, v15, v4 row_ror:8 row_mask:0xf bank_mask:0x8
    v_and_b32_dpp v40, v15, v4 row_ror:8 row_mask:0xf bank_mask:0x1
    v_and_b32_dpp v41, v15, v4 row_ror:12 row_mask:0xf bank_mask:0x2
    v_mfma_f32_16x16x32_bf16 v[16:19], a[244:247], v[44:47], v[16:19]
    v_and_b32_dpp v42, v15, v4 quad_perm:[0,1,2,3] row_mask:0xf bank_mask:0x4
    v_and_b32_dpp v43, v15, v4 row_ror:4 row_mask:0xf bank_mask:0x8
    v_and_b32_dpp v44, v15, v4 row_ror:4 row_mask:0xf bank_mask:0x1
    v_and_b32_dpp v45, v15, v4 row_ror:8 row_mask:0xf bank_mask:0x2
    v_mfma_f32_16x16x32_bf16 v[16:19], a[248:251], v[40:43], v[16:19]
    v_and_b32_dpp v46, v15, v4 row_ror:12 row_mask:0xf bank_mask:0x4
    v_and_b32_dpp v47, v15, v4 quad_perm:[0,1,2,3] row_mask:0xf bank_mask:0x8
    s_nop 1
    v_mfma_f32_16x16x32_bf16 v[16:19], a[252:255], v[44:47], v[16:19]
    s_waitcnt vmcnt(8)
    v_mfma_f32_16x16x32_bf16 v[24:27], v[224:227], v[20:23], 0
    v_mfma_f32_16x16x32_bf16 v[28:31], v[228:231], v[20:23], 0
    v_mfma_f32_16x16x32_bf16 v[32:35], v[232:235], v[20:23], 0
    v_mfma_f32_16x16x32_bf16 v[36:39], v[236:239], v[20:23], 0
    s_nop 4
    v_add_f32_dpp v26, v27, v26 row_ror:12 row_mask:0xf bank_mask:0xf
    v_add_f32_dpp v24, v25, v24 row_ror:12 row_mask:0xf bank_mask:0xf
    v_add_f32_dpp v31, v28, v31 row_ror:12 row_mask:0xf bank_mask:0xf
    v_add_f32_dpp v29, v30, v29 row_ror:12 row_mask:0xf bank_mask:0xf
    v_add_f32_dpp v32, v33, v32 row_ror:12 row_mask:0xf bank_mask:0xf
    v_add_f32_dpp v34, v35, v34 row_ror:12 row_mask:0xf bank_mask:0xf
    v_add_f32_dpp v37, v38, v37 row_ror:12 row_mask:0xf bank_mask:0xf
    v_add_f32_dpp v39, v36, v39 row_ror:12 row_mask:0xf bank_mask:0xf
    v_add_f32_dpp v15, v26, v24 row_ror:8 row_mask:0xf bank_mask:0x1
    v_add_f32_dpp v15, v31, v29 row_ror:8 row_mask:0xf bank_mask:0x2
    v_add_f32_dpp v15, v32, v34 row_ror:8 row_mask:0xf bank_mask:0x4
    v_add_f32_dpp v15, v37, v39 row_ror:8 row_mask:0xf bank_mask:0x8
    v_cvt_pk_bf16_f32 v15, 0, v15
    v_mul_f32 v15, 0x3db504f3, v15
    v_cvt_pk_bf16_f32 v15, 0, v15
    v_cmp_gt_f32 vcc, v15, v12
    s_cbranch_vccnz L_resc_74
L_back_75:
    v_fma_f32 v15, v15, s51, -v13
    v_exp_f32 v15, v15
    s_nop 0
    v_add_f32 v14, v14, v15
    v_cvt_pk_bf16_f32 v15, v15, v15
    s_nop 1
    v_and_b32_dpp v40, v15, v4 quad_perm:[0,1,2,3] row_mask:0xf bank_mask:0x1
    v_and_b32_dpp v41, v15, v4 row_ror:4 row_mask:0xf bank_mask:0x2
    v_and_b32_dpp v42, v15, v4 row_ror:8 row_mask:0xf bank_mask:0x4
    v_and_b32_dpp v43, v15, v4 row_ror:12 row_mask:0xf bank_mask:0x8
    v_and_b32_dpp v44, v15, v4 row_ror:12 row_mask:0xf bank_mask:0x1
    v_and_b32_dpp v45, v15, v4 quad_perm:[0,1,2,3] row_mask:0xf bank_mask:0x2
    v_mfma_f32_16x16x32_bf16 v[16:19], v[240:243], v[40:43], v[16:19]
    v_and_b32_dpp v46, v15, v4 row_ror:4 row_mask:0xf bank_mask:0x4
    v_and_b32_dpp v47, v15, v4 row_ror:8 row_mask:0xf bank_mask:0x8
    v_and_b32_dpp v40, v15, v4 row_ror:8 row_mask:0xf bank_mask:0x1
    v_and_b32_dpp v41, v15, v4 row_ror:12 row_mask:0xf bank_mask:0x2
    v_mfma_f32_16x16x32_bf16 v[16:19], v[244:247], v[44:47], v[16:19]
    v_and_b32_dpp v42, v15, v4 quad_perm:[0,1,2,3] row_mask:0xf bank_mask:0x4
    v_and_b32_dpp v43, v15, v4 row_ror:4 row_mask:0xf bank_mask:0x8
    v_and_b32_dpp v44, v15, v4 row_ror:4 row_mask:0xf bank_mask:0x1
    v_and_b32_dpp v45, v15, v4 row_ror:8 row_mask:0xf bank_mask:0x2
    v_mfma_f32_16x16x32_bf16 v[16:19], v[248:251], v[40:43], v[16:19]
    v_and_b32_dpp v46, v15, v4 row_ror:12 row_mask:0xf bank_mask:0x4
    v_and_b32_dpp v47, v15, v4 quad_perm:[0,1,2,3] row_mask:0xf bank_mask:0x8
    s_nop 1
    v_mfma_f32_16x16x32_bf16 v[16:19], v[252:255], v[44:47], v[16:19]
    s_cmp_lg_u32 s75, 0
    s_cbranch_scc1 L_erp_76
    s_mov_b32 s62, s89
    s_add_u32 s89, s89, s68
    s_add_u32 s88, s88, 1
L_eis_77:
    s_cmp_lg_u32 s67, 1
    s_cbranch_scc1 L_rb_78
    buffer_load_dwordx4 v[224:227], v2, s[4:7], s62 offen offset:0 nt
    buffer_load_dwordx4 v[228:231], v2, s[4:7], s62 offen offset:1024 nt
    buffer_load_dwordx4 v[232:235], v2, s[4:7], s62 offen offset:2048 nt
    buffer_load_dwordx4 v[236:239], v2, s[4:7], s62 offen offset:3072 nt
    buffer_load_dwordx4 v[240:243], v3, s[8:11], s62 offen offset:0
    buffer_load_dwordx4 v[244:247], v3, s[8:11], s62 offen offset:1024
    buffer_load_dwordx4 v[248:251], v3, s[8:11], s62 offen offset:2048
    buffer_load_dwordx4 v[252:255], v3, s[8:11], s62 offen offset:3072
L_re_79:
    v_mfma_f32_16x16x32_bf16 v[24:27], v[64:67], v[20:23], 0
    v_mfma_f32_16x16x32_bf16 v[28:31], v[68:71], v[20:23], 0
    v_mfma_f32_16x16x32_bf16 v[32:35], v[72:75], v[20:23], 0
    v_mfma_f32_16x16x32_bf16 v[36:39], v[76:79], v[20:23], 0
    s_nop 4
    v_add_f32_dpp v26, v27, v26 row_ror:12 row_mask:0xf bank_mask:0xf
    v_add_f32_dpp v24, v25, v24 row_ror:12 row_mask:0xf bank_mask:0xf
    v_add_f32_dpp v31, v28, v31 row_ror:12 row_mask:0xf bank_mask:0xf
    v_add_f32_dpp v29, v30, v29 row_ror:12 row_mask:0xf bank_mask:0xf
    v_add_f32_dpp v32, v33, v32 row_ror:12 row_mask:0xf bank_mask:0xf
    v_add_f32_dpp v34, v35, v34 row_ror:12 row_mask:0xf bank_mask:0xf
    v_add_f32_dpp v37, v38, v37 row_ror:12 row_mask:0xf bank_mask:0xf
    v_add_f32_dpp v39, v36, v39 row_ror:12 row_mask:0xf bank_mask:0xf
    v_add_f32_dpp v15, v26, v24 row_ror:8 row_mask:0xf bank_mask:0x1
    v_add_f32_dpp v15, v31, v29 row_ror:8 row_mask:0xf bank_mask:0x2
    v_add_f32_dpp v15, v32, v34 row_ror:8 row_mask:0xf bank_mask:0x4
    v_add_f32_dpp v15, v37, v39 row_ror:8 row_mask:0xf bank_mask:0x8
    v_cvt_pk_bf16_f32 v15, 0, v15
    v_mul_f32 v15, 0x3db504f3, v15
    v_cvt_pk_bf16_f32 v15, 0, v15
    v_cmp_gt_f32 vcc, v15, v12
    s_cbranch_vccnz L_resc_80
L_back_81:
    v_fma_f32 v15, v15, s51, -v13
    v_exp_f32 v15, v15
    s_nop 0
    v_add_f32 v14, v14, v15
    v_cvt_pk_bf16_f32 v15, v15, v15
    s_nop 1
    v_and_b32_dpp v40, v15, v4 quad_perm:[0,1,2,3] row_mask:0xf bank_mask:0x1
    v_and_b32_dpp v41, v15, v4 row_ror:4 row_mask:0xf bank_mask:0x2
    v_and_b32_dpp v42, v15, v4 row_ror:8 row_mask:0xf bank_mask:0x4
    v_and_b32_dpp v43, v15, v4 row_ror:12 row_mask:0xf bank_mask:0x8
    v_and_b32_dpp v44, v15, v4 row_ror:12 row_mask:0xf bank_mask:0x1
    v_and_b32_dpp v45, v15, v4 quad_perm:[0,1,2,3] row_mask:0xf bank_mask:0x2
    v_mfma_f32_16x16x32_bf16 v[16:19], v[80:83], v[40:43], v[16:19]
    v_and_b32_dpp v46, v15, v4 row_ror:4 row_mask:0xf bank_mask:0x4
    v_and_b32_dpp v47, v15, v4 row_ror:8 row_mask:0xf bank_mask:0x8
    v_and_b32_dpp v40, v15, v4 row_ror:8 row_mask:0xf bank_mask:0x1
    v_and_b32_dpp v41, v15, v4 row_ror:12 row_mask:0xf bank_mask:0x2
    v_mfma_f32_16x16x32_bf16 v[16:19], v[84:87], v[44:47], v[16:19]
    v_and_b32_dpp v42, v15, v4 quad_perm:[0,1,2,3] row_mask:0xf bank_mask:0x4
    v_and_b32_dpp v43, v15, v4 row_ror:4 row_mask:0xf bank_mask:0x8
    v_and_b32_dpp v44, v15, v4 row_ror:4 row_mask:0xf bank_mask:0x1
    v_and_b32_dpp v45, v15, v4 row_ror:8 row_mask:0xf bank_mask:0x2
    v_mfma_f32_16x16x32_bf16 v[16:19], v[88:91], v[40:43], v[16:19]
    v_and_b32_dpp v46, v15, v4 row_ror:12 row_mask:0xf bank_mask:0x4
    v_and_b32_dpp v47, v15, v4 quad_perm:[0,1,2,3] row_mask:0xf bank_mask:0x8
    s_nop 1
    v_mfma_f32_16x16x32_bf16 v[16:19], v[92:95], v[44:47], v[16:19]
    s_waitcnt vmcnt(8)
    v_mfma_f32_16x16x32_bf16 v[24:27], v[192:195], v[20:23], 0
    v_mfma_f32_16x16x32_bf16 v[28:31], v[196:199], v[20:23], 0
    v_mfma_f32_16x16x32_bf16 v[32:35], v[200:203], v[20:23], 0
    v_mfma_f32_16x16x32_bf16 v[36:39], v[204:207], v[20:23], 0
    s_nop 4
    v_add_f32_dpp v26, v27, v26 row_ror:12 row_mask:0xf bank_mask:0xf
    v_add_f32_dpp v24, v25, v24 row_ror:12 row_mask:0xf bank_mask:0xf
    v_add_f32_dpp v31, v28, v31 row_ror:12 row_mask:0xf bank_mask:0xf
    v_add_f32_dpp v29, v30, v29 row_ror:12 row_mask:0xf bank_mask:0xf
    v_add_f32_dpp v32, v33, v32 row_ror:12 row_mask:0xf bank_mask:0xf
    v_add_f32_dpp v34, v35, v34 row_ror:12 row_mask:0xf bank_mask:0xf
    v_add_f32_dpp v37, v38, v37 row_ror:12 row_mask:0xf bank_mask:0xf
    v_add_f32_dpp v39, v36, v39 row_ror:12 row_mask:0xf bank_mask:0xf
    v_add_f32_dpp v15, v26, v24 row_ror:8 row_mask:0xf bank_mask:0x1
    v_add_f32_dpp v15, v31, v29 row_ror:8 row_mask:0xf bank_mask:0x2
    v_add_f32_dpp v15, v32, v34 row_ror:8 row_mask:0xf bank_mask:0x4
    v_add_f32_dpp v15, v37, v39 row_ror:8 row_mask:0xf bank_mask:0x8
    v_cvt_pk_bf16_f32 v15, 0, v15
    v_mul_f32 v15, 0x3db504f3, v15
    v_cvt_pk_bf16_f32 v15, 0, v15
    v_cmp_gt_f32 vcc, v15, v12
    s_cbranch_vccnz L_resc_82
L_back_83:
    v_fma_f32 v15, v15, s51, -v13
    v_exp_f32 v15, v15
    s_nop 0
    v_add_f32 v14, v14, v15
    v_cvt_pk_bf16_f32 v15, v15, v15
    s_nop 1
    v_and_b32_dpp v40, v15, v4 quad_perm:[0,1,2,3] row_mask:0xf bank_mask:0x1
    v_and_b32_dpp v41, v15, v4 row_ror:4 row_mask:0xf bank_mask:0x2
    v_and_b32_dpp v42, v15, v4 row_ror:8 row_mask:0xf bank_mask:0x4
    v_and_b32_dpp v43, v15, v4 row_ror:12 row_mask:0xf bank_mask:0x8
    v_and_b32_dpp v44, v15, v4 row_ror:12 row_mask:0xf bank_mask:0x1
    v_and_b32_dpp v45, v15, v4 quad_perm:[0,1,2,3] row_mask:0xf bank_mask:0x2
    v_mfma_f32_16x16x32_bf16 v[16:19], v[208:211], v[40:43], v[16:19]
    v_and_b32_dpp v46, v15, v4 row_ror:4 row_mask:0xf bank_mask:0x4
    v_and_b32_dpp v47, v15, v4 row_ror:8 row_mask:0xf bank_mask:0x8
    v_and_b32_dpp v40, v15, v4 row_ror:8 row_mask:0xf bank_mask:0x1
    v_and_b32_dpp v41, v15, v4 row_ror:12 row_mask:0xf bank_mask:0x2
    v_mfma_f32_16x16x32_bf16 v[16:19], v[212:215], v[44:47], v[16:19]
    v_and_b32_dpp v42, v15, v4 quad_perm:[0,1,2,3] row_mask:0xf bank_mask:0x4
    v_and_b32_dpp v43, v15, v4 row_ror:4 row_mask:0xf bank_mask:0x8
    v_and_b32_dpp v44, v15, v4 row_ror:4 row_mask:0xf bank_mask:0x1
    v_and_b32_dpp v45, v15, v4 row_ror:8 row_mask:0xf bank_mask:0x2
    v_mfma_f32_16x16x32_bf16 v[16:19], v[216:219], v[40:43], v[16:19]
    v_and_b32_dpp v46, v15, v4 row_ror:12 row_mask:0xf bank_mask:0x4
    v_and_b32_dpp v47, v15, v4 quad_perm:[0,1,2,3] row_mask:0xf bank_mask:0x8
    s_nop 1
    v_mfma_f32_16x16x32_bf16 v[16:19], v[220:223], v[44:47], v[16:19]
    s_cmp_lg_u32 s75, 0
    s_cbranch_scc1 L_erp_84
    s_mov_b32 s62, s89
    s_add_u32 s89, s89, s68
    s_add_u32 s88, s88, 1
L_eis_85:
    s_cmp_lg_u32 s67, 1
    s_cbranch_scc1 L_rb_86
    buffer_load_dwordx4 v[192:195], v2, s[4:7], s62 offen offset:0 nt
    buffer_load_dwordx4 v[196:199], v2, s[4:7], s62 offen offset:1024 nt
    buffer_load_dwordx4 v[200:203], v2, s[4:7], s62 offen offset:2048 nt
    buffer_load_dwordx4 v[204:207], v2, s[4:7], s62 offen offset:3072 nt
    buffer_load_dwordx4 v[208:211], v3, s[8:11], s62 offen offset:0
    buffer_load_dwordx4 v[212:215], v3, s[8:11], s62 offen offset:1024
    buffer_load_dwordx4 v[216:219], v3, s[8:11], s62 offen offset:2048
    buffer_load_dwordx4 v[220:223], v3, s[8:11], s62 offen offset:3072
L_re_87:
    v_mfma_f32_16x16x32_bf16 v[24:27], v[96:99], v[20:23], 0
    v_mfma_f32_16x16x32_bf16 v[28:31], v[100:103], v[20:23], 0
    v_mfma_f32_16x16x32_bf16 v[32:35], v[104:107], v[20:23], 0
    v_mfma_f32_16x16x32_bf16 v[36:39], v[108:111], v[20:23], 0
    s_nop 4
    v_add_f32_dpp v26, v27, v26 row_ror:12 row_mask:0xf bank_mask:0xf
    v_add_f32_dpp v24, v25, v24 row_ror:12 row_mask:0xf bank_mask:0xf
    v_add_f32_dpp v31, v28, v31 row_ror:12 row_mask:0xf bank_mask:0xf
    v_add_f32_dpp v29, v30, v29 row_ror:12 row_mask:0xf bank_mask:0xf
    v_add_f32_dpp v32, v33, v32 row_ror:12 row_mask:0xf bank_mask:0xf
    v_add_f32_dpp v34, v35, v34 row_ror:12 row_mask:0xf bank_mask:0xf
    v_add_f32_dpp v37, v38, v37 row_ror:12 row_mask:0xf bank_mask:0xf
    v_add_f32_dpp v39, v36, v39 row_ror:12 row_mask:0xf bank_mask:0xf
    v_add_f32_dpp v15, v26, v24 row_ror:8 row_mask:0xf bank_mask:0x1
    v_add_f32_dpp v15, v31, v29 row_ror:8 row_mask:0xf bank_mask:0x2
    v_add_f32_dpp v15, v32, v34 row_ror:8 row_mask:0xf bank_mask:0x4
    v_add_f32_dpp v15, v37, v39 row_ror:8 row_mask:0xf bank_mask:0x8
    v_cvt_pk_bf16_f32 v15, 0, v15
    v_mul_f32 v15, 0x3db504f3, v15
    v_cvt_pk_bf16_f32 v15, 0, v15
    v_cmp_gt_f32 vcc, v15, v12
    s_cbranch_vccnz L_resc_88
L_back_89:
    v_fma_f32 v15, v15, s51, -v13
    v_exp_f32 v15, v15
    s_nop 0
    v_add_f32 v14, v14, v15
    v_cvt_pk_bf16_f32 v15, v15, v15
    s_nop 1
    v_and_b32_dpp v40, v15, v4 quad_perm:[0,1,2,3] row_mask:0xf bank_mask:0x1
    v_and_b32_dpp v41, v15, v4 row_ror:4 row_mask:0xf bank_mask:0x2
    v_and_b32_dpp v42, v15, v4 row_ror:8 row_mask:0xf bank_mask:0x4
    v_and_b32_dpp v43, v15, v4 row_ror:12 row_mask:0xf bank_mask:0x8
    v_and_b32_dpp v44, v15, v4 row_ror:12 row_mask:0xf bank_mask:0x1
    v_and_b32_dpp v45, v15, v4 quad_perm:[0,1,2,3] row_mask:0xf bank_mask:0x2
    v_mfma_f32_16x16x32_bf16 v[16:19], v[112:115], v[40:43], v[16:19]
    v_and_b32_dpp v46, v15, v4 row_ror:4 row_mask:0xf bank_mask:0x4
    v_and_b32_dpp v47, v15, v4 row_ror:8 row_mask:0xf bank_mask:0x8
    v_and_b32_dpp v40, v15, v4 row_ror:8 row_mask:0xf bank_mask:0x1
    v_and_b32_dpp v41, v15, v4 row_ror:12 row_mask:0xf bank_mask:0x2
    v_mfma_f32_16x16x32_bf16 v[16:19], v[116:119], v[44:47], v[16:19]
    v_and_b32_dpp v42, v15, v4 quad_perm:[0,1,2,3] row_mask:0xf bank_mask:0x4
    v_and_b32_dpp v43, v15, v4 row_ror:4 row_mask:0xf bank_mask:0x8
    v_and_b32_dpp v44, v15, v4 row_ror:4 row_mask:0xf bank_mask:0x1
    v_and_b32_dpp v45, v15, v4 row_ror:8 row_mask:0xf bank_mask:0x2
    v_mfma_f32_16x16x32_bf16 v[16:19], v[120:123], v[40:43], v[16:19]
    v_and_b32_dpp v46, v15, v4 row_ror:12 row_mask:0xf bank_mask:0x4
    v_and_b32_dpp v47, v15, v4 quad_perm:[0,1,2,3] row_mask:0xf bank_mask:0x8
    s_nop 1
    v_mfma_f32_16x16x32_bf16 v[16:19], v[124:127], v[44:47], v[16:19]
    v_mfma_f32_16x16x32_bf16 v[24:27], v[128:131], v[20:23], 0
    v_mfma_f32_16x16x32_bf16 v[28:31], v[132:135], v[20:23], 0
    v_mfma_f32_16x16x32_bf16 v[32:35], v[136:139], v[20:23], 0
    v_mfma_f32_16x16x32_bf16 v[36:39], v[140:143], v[20:23], 0
    s_nop 4
    v_add_f32_dpp v26, v27, v26 row_ror:12 row_mask:0xf bank_mask:0xf
    v_add_f32_dpp v24, v25, v24 row_ror:12 row_mask:0xf bank_mask:0xf
    v_add_f32_dpp v31, v28, v31 row_ror:12 row_mask:0xf bank_mask:0xf
    v_add_f32_dpp v29, v30, v29 row_ror:12 row_mask:0xf bank_mask:0xf
    v_add_f32_dpp v32, v33, v32 row_ror:12 row_mask:0xf bank_mask:0xf
    v_add_f32_dpp v34, v35, v34 row_ror:12 row_mask:0xf bank_mask:0xf
    v_add_f32_dpp v37, v38, v37 row_ror:12 row_mask:0xf bank_mask:0xf
    v_add_f32_dpp v39, v36, v39 row_ror:12 row_mask:0xf bank_mask:0xf
    v_add_f32_dpp v15, v26, v24 row_ror:8 row_mask:0xf bank_mask:0x1
    v_add_f32_dpp v15, v31, v29 row_ror:8 row_mask:0xf bank_mask:0x2
    v_add_f32_dpp v15, v32, v34 row_ror:8 row_mask:0xf bank_mask:0x4
    v_add_f32_dpp v15, v37, v39 row_ror:8 row_mask:0xf bank_mask:0x8
    v_cvt_pk_bf16_f32 v15, 0, v15
    v_mul_f32 v15, 0x3db504f3, v15
    v_cvt_pk_bf16_f32 v15, 0, v15
    v_cmp_gt_f32 vcc, v15, v12
    s_cbranch_vccnz L_resc_90
L_back_91:
    v_fma_f32 v15, v15, s51, -v13
    v_exp_f32 v15, v15
    s_nop 0
    v_add_f32 v14, v14, v15
    v_cvt_pk_bf16_f32 v15, v15, v15
    s_nop 1
    v_and_b32_dpp v40, v15, v4 quad_perm:[0,1,2,3] row_mask:0xf bank_mask:0x1
    v_and_b32_dpp v41, v15, v4 row_ror:4 row_mask:0xf bank_mask:0x2
    v_and_b32_dpp v42, v15, v4 row_ror:8 row_mask:0xf bank_mask:0x4
    v_and_b32_dpp v43, v15, v4 row_ror:12 row_mask:0xf bank_mask:0x8
    v_and_b32_dpp v44, v15, v4 row_ror:12 row_mask:0xf bank_mask:0x1
    v_and_b32_dpp v45, v15, v4 quad_perm:[0,1,2,3] row_mask:0xf bank_mask:0x2
    v_mfma_f32_16x16x32_bf16 v[16:19], v[144:147], v[40:43], v[16:19]
    v_and_b32_dpp v46, v15, v4 row_ror:4 row_mask:0xf bank_mask:0x4
    v_and_b32_dpp v47, v15, v4 row_ror:8 row_mask:0xf bank_mask:0x8
    v_and_b32_dpp v40, v15, v4 row_ror:8 row_mask:0xf bank_mask:0x1
    v_and_b32_dpp v41, v15, v4 row_ror:12 row_mask:0xf bank_mask:0x2
    v_mfma_f32_16x16x32_bf16 v[16:19], v[148:151], v[44:47], v[16:19]
    v_and_b32_dpp v42, v15, v4 quad_perm:[0,1,2,3] row_mask:0xf bank_mask:0x4
    v_and_b32_dpp v43, v15, v4 row_ror:4 row_mask:0xf bank_mask:0x8
    v_and_b32_dpp v44, v15, v4 row_ror:4 row_mask:0xf bank_mask:0x1
    v_and_b32_dpp v45, v15, v4 row_ror:8 row_mask:0xf bank_mask:0x2
    v_mfma_f32_16x16x32_bf16 v[16:19], v[152:155], v[40:43], v[16:19]
    v_and_b32_dpp v46, v15, v4 row_ror:12 row_mask:0xf bank_mask:0x4
    v_and_b32_dpp v47, v15, v4 quad_perm:[0,1,2,3] row_mask:0xf bank_mask:0x8
    s_nop 1
    v_mfma_f32_16x16x32_bf16 v[16:19], v[156:159], v[44:47], v[16:19]
    s_waitcnt vmcnt(8)
    v_mfma_f32_16x16x32_bf16 v[24:27], v[224:227], v[20:23], 0
    v_mfma_f32_16x16x32_bf16 v[28:31], v[228:231], v[20:23], 0
    v_mfma_f32_16x16x32_bf16 v[32:35], v[232:235], v[20:23], 0
    v_mfma_f32_16x16x32_bf16 v[36:39], v[236:239], v[20:23], 0
    s_nop 4
    v_add_f32_dpp v26, v27, v26 row_ror:12 row_mask:0xf bank_mask:0xf
    v_add_f32_dpp v24, v25, v24 row_ror:12 row_mask:0xf bank_mask:0xf
    v_add_f32_dpp v31, v28, v31 row_ror:12 row_mask:0xf bank_mask:0xf
    v_add_f32_dpp v29, v30, v29 row_ror:12 row_mask:0xf bank_mask:0xf
    v_add_f32_dpp v32, v33, v32 row_ror:12 row_mask:0xf bank_mask:0xf
    v_add_f32_dpp v34, v35, v34 row_ror:12 row_mask:0xf bank_mask:0xf
    v_add_f32_dpp v37, v38, v37 row_ror:12 row_mask:0xf bank_mask:0xf
    v_add_f32_dpp v39, v36, v39 row_ror:12 row_mask:0xf bank_mask:0xf
    v_add_f32_dpp v15, v26, v24 row_ror:8 row_mask:0xf bank_mask:0x1
    v_add_f32_dpp v15, v31, v29 row_ror:8 row_mask:0xf bank_mask:0x2
    v_add_f32_dpp v15, v32, v34 row_ror:8 row_mask:0xf bank_mask:0x4
    v_add_f32_dpp v15, v37, v39 row_ror:8 row_mask:0xf bank_mask:0x8
    v_cvt_pk_bf16_f32 v15, 0, v15
    v_mul_f32 v15, 0x3db504f3, v15
    v_cvt_pk_bf16_f32 v15, 0, v15
    v_cmp_gt_f32 vcc, v15, v12
    s_cbranch_vccnz L_resc_92
L_back_93:
    v_fma_f32 v15, v15, s51, -v13
    v_exp_f32 v15, v15
    s_nop 0
    v_add_f32 v14, v14, v15
    v_cvt_pk_bf16_f32 v15, v15, v15
    s_nop 1
    v_and_b32_dpp v40, v15, v4 quad_perm:[0,1,2,3] row_mask:0xf bank_mask:0x1
    v_and_b32_dpp v41, v15, v4 row_ror:4 row_mask:0xf bank_mask:0x2
    v_and_b32_dpp v42, v15, v4 row_ror:8 row_mask:0xf bank_mask:0x4
    v_and_b32_dpp v43, v15, v4 row_ror:12 row_mask:0xf bank_mask:0x8
    v_and_b32_dpp v44, v15, v4 row_ror:12 row_mask:0xf bank_mask:0x1
    v_and_b32_dpp v45, v15, v4 quad_perm:[0,1,2,3] row_mask:0xf bank_mask:0x2
    v_mfma_f32_16x16x32_bf16 v[16:19], v[240:243], v[40:43], v[16:19]
    v_and_b32_dpp v46, v15, v4 row_ror:4 row_mask:0xf bank_mask:0x4
    v_and_b32_dpp v47, v15, v4 row_ror:8 row_mask:0xf bank_mask:0x8
    v_and_b32_dpp v40, v15, v4 row_ror:8 row_mask:0xf bank_mask:0x1
    v_and_b32_dpp v41, v15, v4 row_ror:12 row_mask:0xf bank_mask:0x2
    v_mfma_f32_16x16x32_bf16 v[16:19], v[244:247], v[44:47], v[16:19]
    v_and_b32_dpp v42, v15, v4 quad_perm:[0,1,2,3] row_mask:0xf bank_mask:0x4
    v_and_b32_dpp v43, v15, v4 row_ror:4 row_mask:0xf bank_mask:0x8
    v_and_b32_dpp v44, v15, v4 row_ror:4 row_mask:0xf bank_mask:0x1
    v_and_b32_dpp v45, v15, v4 row_ror:8 row_mask:0xf bank_mask:0x2
    v_mfma_f32_16x16x32_bf16 v[16:19], v[248:251], v[40:43], v[16:19]
    v_and_b32_dpp v46, v15, v4 row_ror:12 row_mask:0xf bank_mask:0x4
    v_and_b32_dpp v47, v15, v4 quad_perm:[0,1,2,3] row_mask:0xf bank_mask:0x8
    s_nop 1
    v_mfma_f32_16x16x32_bf16 v[16:19], v[252:255], v[44:47], v[16:19]
    s_cmp_lg_u32 s75, 0
    s_cbranch_scc1 L_erp_94
    s_mov_b32 s62, s89
    s_add_u32 s89, s89, s68
    s_add_u32 s88, s88, 1
L_eis_95:
    s_cmp_lg_u32 s67, 1
    s_cbranch_scc1 L_rb_96
    buffer_load_dwordx4 v[224:227], v2, s[4:7], s62 offen offset:0 nt
    buffer_load_dwordx4 v[228:231], v2, s[4:7], s62 offen offset:1024 nt
    buffer_load_dwordx4 v[232:235], v2, s[4:7], s62 offen offset:2048 nt
    buffer_load_dwordx4 v[236:239], v2, s[4:7], s62 offen offset:3072 nt
    buffer_load_dwordx4 v[240:243], v3, s[8:11], s62 offen offset:0
    buffer_load_dwordx4 v[244:247], v3, s[8:11], s62 offen offset:1024
    buffer_load_dwordx4 v[248:251], v3, s[8:11], s62 offen offset:2048
    buffer_load_dwordx4 v[252:255], v3, s[8:11], s62 offen offset:3072
L_re_97:
    v_mfma_f32_16x16x32_bf16 v[24:27], v[160:163], v[20:23], 0
    v_mfma_f32_16x16x32_bf16 v[28:31], v[164:167], v[20:23], 0
    v_mfma_f32_16x16x32_bf16 v[32:35], v[168:171], v[20:23], 0
    v_mfma_f32_16x16x32_bf16 v[36:39], v[172:175], v[20:23], 0
    s_nop 4
    v_add_f32_dpp v26, v27, v26 row_ror:12 row_mask:0xf bank_mask:0xf
    v_add_f32_dpp v24, v25, v24 row_ror:12 row_mask:0xf bank_mask:0xf
    v_add_f32_dpp v31, v28, v31 row_ror:12 row_mask:0xf bank_mask:0xf
    v_add_f32_dpp v29, v30, v29 row_ror:12 row_mask:0xf bank_mask:0xf
    v_add_f32_dpp v32, v33, v32 row_ror:12 row_mask:0xf bank_mask:0xf
    v_add_f32_dpp v34, v35, v34 row_ror:12 row_mask:0xf bank_mask:0xf
    v_add_f32_dpp v37, v38, v37 row_ror:12 row_mask:0xf bank_mask:0xf
    v_add_f32_dpp v39, v36, v39 row_ror:12 row_mask:0xf bank_mask:0xf
    v_add_f32_dpp v15, v26, v24 row_ror:8 row_mask:0xf bank_mask:0x1
    v_add_f32_dpp v15, v31, v29 row_ror:8 row_mask:0xf bank_mask:0x2
    v_add_f32_dpp v15, v32, v34 row_ror:8 row_mask:0xf bank_mask:0x4
    v_add_f32_dpp v15, v37, v39 row_ror:8 row_mask:0xf bank_mask:0x8
    v_cvt_pk_bf16_f32 v15, 0, v15
    v_mul_f32 v15, 0x3db504f3, v15
    v_cvt_pk_bf16_f32 v15, 0, v15
    v_cmp_gt_f32 vcc, v15, v12
    s_cbranch_vccnz L_resc_98
L_back_99:
    v_fma_f32 v15, v15, s51, -v13
    v_exp_f32 v15, v15
    s_nop 0
    v_add_f32 v14, v14, v15
    v_cvt_pk_bf16_f32 v15, v15, v15
    s_nop 1
    v_and_b32_dpp v40, v15, v4 quad_perm:[0,1,2,3] row_mask:0xf bank_mask:0x1
    v_and_b32_dpp v41, v15, v4 row_ror:4 row_mask:0xf bank_mask:0x2
    v_and_b32_dpp v42, v15, v4 row_ror:8 row_mask:0xf bank_mask:0x4
    v_and_b32_dpp v43, v15, v4 row_ror:12 row_mask:0xf bank_mask:0x8
    v_and_b32_dpp v44, v15, v4 row_ror:12 row_mask:0xf bank_mask:0x1
    v_and_b32_dpp v45, v15, v4 quad_perm:[0,1,2,3] row_mask:0xf bank_mask:0x2
    v_mfma_f32_16x16x32_bf16 v[16:19], v[176:179], v[40:43], v[16:19]
    v_and_b32_dpp v46, v15, v4 row_ror:4 row_mask:0xf bank_mask:0x4
    v_and_b32_dpp v47, v15, v4 row_ror:8 row_mask:0xf bank_mask:0x8
    v_and_b32_dpp v40, v15, v4 row_ror:8 row_mask:0xf bank_mask:0x1
    v_and_b32_dpp v41, v15, v4 row_ror:12 row_mask:0xf bank_mask:0x2
    v_mfma_f32_16x16x32_bf16 v[16:19], v[180:183], v[44:47], v[16:19]
    v_and_b32_dpp v42, v15, v4 quad_perm:[0,1,2,3] row_mask:0xf bank_mask:0x4
    v_and_b32_dpp v43, v15, v4 row_ror:4 row_mask:0xf bank_mask:0x8
    v_and_b32_dpp v44, v15, v4 row_ror:4 row_mask:0xf bank_mask:0x1
    v_and_b32_dpp v45, v15, v4 row_ror:8 row_mask:0xf bank_mask:0x2
    v_mfma_f32_16x16x32_bf16 v[16:19], v[184:187], v[40:43], v[16:19]
    v_and_b32_dpp v46, v15, v4 row_ror:12 row_mask:0xf bank_mask:0x4
    v_and_b32_dpp v47, v15, v4 quad_perm:[0,1,2,3] row_mask:0xf bank_mask:0x8
    s_nop 1
    v_mfma_f32_16x16x32_bf16 v[16:19], v[188:191], v[44:47], v[16:19]
L_ring:
    s_cmp_eq_u32 s56, 2
    s_cbranch_scc1 L_w_100
    s_waitcnt vmcnt(0)
L_w_100:
    s_waitcnt vmcnt(8)
    v_mfma_f32_16x16x32_bf16 v[24:27], v[192:195], v[20:23], 0
    v_mfma_f32_16x16x32_bf16 v[28:31], v[196:199], v[20:23], 0
    v_mfma_f32_16x16x32_bf16 v[32:35], v[200:203], v[20:23], 0
    v_mfma_f32_16x16x32_bf16 v[36:39], v[204:207], v[20:23], 0
    s_nop 4
    v_add_f32_dpp v26, v27, v26 row_ror:12 row_mask:0xf bank_mask:0xf
    v_add_f32_dpp v24, v25, v24 row_ror:12 row_mask:0xf bank_mask:0xf
    v_add_f32_dpp v31, v28, v31 row_ror:12 row_mask:0xf bank_mask:0xf
    v_add_f32_dpp v29, v30, v29 row_ror:12 row_mask:0xf bank_mask:0xf
    v_add_f32_dpp v32, v33, v32 row_ror:12 row_mask:0xf bank_mask:0xf
    v_add_f32_dpp v34, v35, v34 row_ror:12 row_mask:0xf bank_mask:0xf
    v_add_f32_dpp v37, v38, v37 row_ror:12 row_mask:0xf bank_mask:0xf
    v_add_f32_dpp v39, v36, v39 row_ror:12 row_mask:0xf bank_mask:0xf
    v_add_f32_dpp v15, v26, v24 row_ror:8 row_mask:0xf bank_mask:0x1
    v_add_f32_dpp v15, v31, v29 row_ror:8 row_mask:0xf bank_mask:0x2
    v_add_f32_dpp v15, v32, v34 row_ror:8 row_mask:0xf bank_mask:0x4
    v_add_f32_dpp v15, v37, v39 row_ror:8 row_mask:0xf bank_mask:0x8
    v_cvt_pk_bf16_f32 v15, 0, v15
    v_mul_f32 v15, 0x3db504f3, v15
    v_cvt_pk_bf16_f32 v15, 0, v15
    v_cmp_gt_f32 vcc, v15, v12
    s_cbranch_vccnz L_resc_101
L_back_102:
    v_fma_f32 v15, v15, s51, -v13
    v_exp_f32 v15, v15
    s_nop 0
    v_add_f32 v14, v14, v15
    v_cvt_pk_bf16_f32 v15, v15, v15
    s_nop 1
    v_and_b32_dpp v40, v15, v4 quad_perm:[0,1,2,3] row_mask:0xf bank_mask:0x1
    v_and_b32_dpp v41, v15, v4 row_ror:4 row_mask:0xf bank_mask:0x2
    v_and_b32_dpp v42, v15, v4 row_ror:8 row_mask:0xf bank_mask:0x4
    v_and_b32_dpp v43, v15, v4 row_ror:12 row_mask:0xf bank_mask:0x8
    v_and_b32_dpp v44, v15, v4 row_ror:12 row_mask:0xf bank_mask:0x1
    v_and_b32_dpp v45, v15, v4 quad_perm:[0,1,2,3] row_mask:0xf bank_mask:0x2
    v_mfma_f32_16x16x32_bf16 v[16:19], v[208:211], v[40:43], v[16:19]
    v_and_b32_dpp v46, v15, v4 row_ror:4 row_mask:0xf bank_mask:0x4
    v_and_b32_dpp v47, v15, v4 row_ror:8 row_mask:0xf bank_mask:0x8
    v_and_b32_dpp v40, v15, v4 row_ror:8 row_mask:0xf bank_mask:0x1
    v_and_b32_dpp v41, v15, v4 row_ror:12 row_mask:0xf bank_mask:0x2
    v_mfma_f32_16x16x32_bf16 v[16:19], v[212:215], v[44:47], v[16:19]
    v_and_b32_dpp v42, v15, v4 quad_perm:[0,1,2,3] row_mask:0xf bank_mask:0x4
    v_and_b32_dpp v43, v15, v4 row_ror:4 row_mask:0xf bank_mask:0x8
    v_and_b32_dpp v44, v15, v4 row_ror:4 row_mask:0xf bank_mask:0x1
    v_and_b32_dpp v45, v15, v4 row_ror:8 row_mask:0xf bank_mask:0x2
    v_mfma_f32_16x16x32_bf16 v[16:19], v[216:219], v[40:43], v[16:19]
    v_and_b32_dpp v46, v15, v4 row_ror:12 row_mask:0xf bank_mask:0x4
    v_and_b32_dpp v47, v15, v4 quad_perm:[0,1,2,3] row_mask:0xf bank_mask:0x8
    s_nop 1
    v_mfma_f32_16x16x32_bf16 v[16:19], v[220:223], v[44:47], v[16:19]
    s_cmp_lg_u32 s75, 0
    s_cbranch_scc1 L_rp_109
    s_cmp_ge_u32 s88, s69
    s_cbranch_scc1 L_dyn_104
    s_mov_b32 s62, s89
    s_add_u32 s89, s89, s68
    s_add_u32 s88, s88, 1
    s_cmp_eq_u32 s88, s69
    s_cbranch_scc1 L_req_108
L_iss_103:
    s_cmp_lg_u32 s67, 1
    s_cbranch_scc1 L_rb_110
    s_waitcnt vmcnt(5)
    buffer_load_dwordx4 v[192:195], v2, s[4:7], s62 offen offset:0 nt
    s_waitcnt vmcnt(5)
    buffer_load_dwordx4 v[196:199], v2, s[4:7], s62 offen offset:1024 nt
    s_waitcnt vmcnt(5)
    buffer_load_dwordx4 v[200:203], v2, s[4:7], s62 offen offset:2048 nt
    s_waitcnt vmcnt(5)
    buffer_load_dwordx4 v[204:207], v2, s[4:7], s62 offen offset:3072 nt
    s_waitcnt vmcnt(5)
    buffer_load_dwordx4 v[208:211], v3, s[8:11], s62 offen offset:0
    s_waitcnt vmcnt(5)
    buffer_load_dwordx4 v[212:215], v3, s[8:11], s62 offen offset:1024
    s_waitcnt vmcnt(5)
    buffer_load_dwordx4 v[216:219], v3, s[8:11], s62 offen offset:2048
    s_waitcnt vmcnt(5)
    buffer_load_dwordx4 v[220:223], v3, s[8:11], s62 offen offset:3072
L_re_111:
L_nxt_105:
    s_cmp_eq_u32 s56, 2
    s_cbranch_scc1 L_w_114
    s_waitcnt vmcnt(0)
L_w_114:
    s_waitcnt vmcnt(8)
    v_mfma_f32_16x16x32_bf16 v[24:27], v[224:227], v[20:23], 0
    v_mfma_f32_16x16x32_bf16 v[28:31], v[228:231], v[20:23], 0
    v_mfma_f32_16x16x32_bf16 v[32:35], v[232:235], v[20:23], 0
    v_mfma_f32_16x16x32_bf16 v[36:39], v[236:239], v[20:23], 0
    s_nop 4
    v_add_f32_dpp v26, v27, v26 row_ror:12 row_mask:0xf bank_mask:0xf
    v_add_f32_dpp v24, v25, v24 row_ror:12 row_mask:0xf bank_mask:0xf
    v_add_f32_dpp v31, v28, v31 row_ror:12 row_mask:0xf bank_mask:0xf
    v_add_f32_dpp v29, v30, v29 row_ror:12 row_mask:0xf bank_mask:0xf
    v_add_f32_dpp v32, v33, v32 row_ror:12 row_mask:0xf bank_mask:0xf
    v_add_f32_dpp v34, v35, v34 row_ror:12 row_mask:0xf bank_mask:0xf
    v_add_f32_dpp v37, v38, v37 row_ror:12 row_mask:0xf bank_mask:0xf
    v_add_f32_dpp v39, v36, v39 row_ror:12 row_mask:0xf bank_mask:0xf
    v_add_f32_dpp v15, v26, v24 row_ror:8 row_mask:0xf bank_mask:0x1
    v_add_f32_dpp v15, v31, v29 row_ror:8 row_mask:0xf bank_mask:0x2
    v_add_f32_dpp v15, v32, v34 row_ror:8 row_mask:0xf bank_mask:0x4
    v_add_f32_dpp v15, v37, v39 row_ror:8 row_mask:0xf bank_mask:0x8
    v_cvt_pk_bf16_f32 v15, 0, v15
    v_mul_f32 v15, 0x3db504f3, v15
    v_cvt_pk_bf16_f32 v15, 0, v15
    v_cmp_gt_f32 vcc, v15, v12
    s_cbranch_vccnz L_resc_115
L_back_116:
    v_fma_f32 v15, v15, s51, -v13
    v_exp_f32 v15, v15
    s_nop 0
    v_add_f32 v14, v14, v15
    v_cvt_pk_bf16_f32 v15, v15, v15
    s_nop 1
    v_and_b32_dpp v40, v15, v4 quad_perm:[0,1,2,3] row_mask:0xf bank_mask:0x1
    v_and_b32_dpp v41, v15, v4 row_ror:4 row_mask:0xf bank_mask:0x2
    v_and_b32_dpp v42, v15, v4 row_ror:8 row_mask:0xf bank_mask:0x4
    v_and_b32_dpp v43, v15, v4 row_ror:12 row_mask:0xf bank_mask:0x8
    v_and_b32_dpp v44, v15, v4 row_ror:12 row_mask:0xf bank_mask:0x1
    v_and_b32_dpp v45, v15, v4 quad_perm:[0,1,2,3] row_mask:0xf bank_mask:0x2
    v_mfma_f32_16x16x32_bf16 v[16:19], v[240:243], v[40:43], v[16:19]
    v_and_b32_dpp v46, v15, v4 row_ror:4 row_mask:0xf bank_mask:0x4
    v_and_b32_dpp v47, v15, v4 row_ror:8 row_mask:0xf bank_mask:0x8
    v_and_b32_dpp v40, v15, v4 row_ror:8 row_mask:0xf bank_mask:0x1
    v_and_b32_dpp v41, v15, v4 row_ror:12 row_mask:0xf bank_mask:0x2
    v_mfma_f32_16x16x32_bf16 v[16:19], v[244:247], v[44:47], v[16:19]
    v_and_b32_dpp v42, v15, v4 quad_perm:[0,1,2,3] row_mask:0xf bank_mask:0x4
    v_and_b32_dpp v43, v15, v4 row_ror:4 row_mask:0xf bank_mask:0x8
    v_and_b32_dpp v44, v15, v4 row_ror:4 row_mask:0xf bank_mask:0x1
    v_and_b32_dpp v45, v15, v4 row_ror:8 row_mask:0xf bank_mask:0x2
    v_mfma_f32_16x16x32_bf16 v[16:19], v[248:251], v[40:43], v[16:19]
    v_and_b32_dpp v46, v15, v4 row_ror:12 row_mask:0xf bank_mask:0x4
    v_and_b32_dpp v47, v15, v4 quad_perm:[0,1,2,3] row_mask:0xf bank_mask:0x8
    s_nop 1
    v_mfma_f32_16x16x32_bf16 v[16:19], v[252:255], v[44:47], v[16:19]
    s_cmp_lg_u32 s75, 0
    s_cbranch_scc1 L_rp_123
    s_cmp_ge_u32 s88, s69
    s_cbranch_scc1 L_dyn_118
    s_mov_b32 s62, s89
    s_add_u32 s89, s89, s68
    s_add_u32 s88, s88, 1
    s_cmp_eq_u32 s88, s69
    s_cbranch_scc1 L_req_122
L_iss_117:
    s_cmp_lg_u32 s67, 1
    s_cbranch_scc1 L_rb_124
    s_waitcnt vmcnt(5)
    buffer_load_dwordx4 v[224:227], v2, s[4:7], s62 offen offset:0 nt
    s_waitcnt vmcnt(5)
    buffer_load_dwordx4 v[228:231], v2, s[4:7], s62 offen offset:1024 nt
    s_waitcnt vmcnt(5)
    buffer_load_dwordx4 v[232:235], v2, s[4:7], s62 offen offset:2048 nt
    s_waitcnt vmcnt(5)
    buffer_load_dwordx4 v[236:239], v2, s[4:7], s62 offen offset:3072 nt
    s_waitcnt vmcnt(5)
    buffer_load_dwordx4 v[240:243], v3, s[8:11], s62 offen offset:0
    s_waitcnt vmcnt(5)
    buffer_load_dwordx4 v[244:247], v3, s[8:11], s62 offen offset:1024
    s_waitcnt vmcnt(5)
    buffer_load_dwordx4 v[248:251], v3, s[8:11], s62 offen offset:2048
    s_waitcnt vmcnt(5)
    buffer_load_dwordx4 v[252:255], v3, s[8:11], s62 offen offset:3072
L_re_125:
L_nxt_119:
    s_branch L_ring
L_pass_end:
    v_add_f32_dpp v14, v14, v14 row_ror:12 row_mask:0xf bank_mask:0xf
    v_and_b32 v36, 1, v1
    v_lshlrev_b32 v37, 9, v36
    v_add_f32_dpp v14, v14, v14 row_ror:8 row_mask:0xf bank_mask:0xf
    v_lshrrev_b32 v38, 4, v1
    v_mov_b32 v39, v14
    v_lshl_add_u32 v37, v38, 7, v37
    v_bfe_u32 v38, v1, 1, 3
    v_permlane16_swap_b32 v14, v39
    v_lshl_add_u32 v37, v38, 2, v37
    v_add_f32 v14, v14, v39
    s_lshl_b32 s52, s3, 10
    v_mov_b32 v39, v14
    v_add_u32 v37, s52, v37
    s_lshl_b32 s52, s3, 4
    v_permlane32_swap_b32 v14, v39
    ds_write_b32 v37, v16 offset:0
    ds_write_b32 v37, v17 offset:32
    ds_write_b32 v37, v18 offset:64
    ds_write_b32 v37, v19 offset:96
    v_lshl_add_u32 v38, v36, 3, s52
    v_add_f32 v41, v14, v39
    v_mov_b32 v40, v13
    s_mov_b64 exec, 3
    ds_write_b64 v38, v[40:41] offset:4096
    s_mov_b64 exec, -1
    s_and_b32 s53, s3, 1
    v_lshrrev_b32 v5, 5, v1
    v_mul_u32_u24 v5, 1152, v5
    s_lshl_b32 s54, s53, 3
    v_and_b32 v6, 15, v1
    v_mul_u32_u24 v6, 1152, v6
    v_add_u32 v6, s54, v6
    v_and_b32 v7, 31, v1
    v_lshl_add_u32 v5, v7, 4, v5
    s_lshl_b32 s54, s53, 9
    v_add_u32 v5, s54, v5
    s_lshl_b32 s52, s3, 8
    v_lshl_add_u32 v7, v7, 3, s52
    v_lshlrev_b32 v12, 4, v1
    v_lshrrev_b32 v14, 5, v1
    v_lshlrev_b32 v14, 3, v14
    s_mov_b32 s59, 0
    s_waitcnt lgkmcnt(0)
    s_barrier
    s_cmp_lg_u32 s3, 0
    s_cbranch_scc1 L_h1
    ds_read_b64 v[16:17], v14 offset:4096
    ds_read_b64 v[18:19], v14 offset:4112
    ds_read_b64 v[20:21], v14 offset:4128
    ds_read_b64 v[22:23], v14 offset:4144
    ds_read_b128 v[24:27], v12 offset:0
    ds_read_b128 v[28:31], v12 offset:1024
    ds_read_b128 v[32:35], v12 offset:2048
    ds_read_b128 v[36:39], v12 offset:3072
    s_waitcnt lgkmcnt(4)
    v_max3_f32 v40, v16, v18, v20
    v_max_f32 v40, v40, v22
    v_sub_f32 v16, v16, v40
    v_sub_f32 v18, v18, v40
    v_sub_f32 v20, v20, v40
    v_sub_f32 v22, v22, v40
    v_exp_f32 v16, v16
    v_exp_f32 v18, v18
    v_exp_f32 v20, v20
    v_exp_f32 v22, v22
    v_mul_f32 v41, v16, v17
    v_fmac_f32 v41, v18, v19
    v_fmac_f32 v41, v20, v21
    v_fmac_f32 v41, v22, v23
    s_waitcnt lgkmcnt(0)
    v_pk_mul_f32 v[44:45], v[16:17], v[24:25] op_sel_hi:[0,1]
    v_pk_mul_f32 v[46:47], v[16:17], v[26:27] op_sel_hi:[0,1]
    v_pk_fma_f32 v[44:45], v[18:19], v[28:29], v[44:45] op_sel_hi:[0,1,1]
    v_pk_fma_f32 v[46:47], v[18:19], v[30:31], v[46:47] op_sel_hi:[0,1,1]
    v_pk_fma_f32 v[44:45], v[20:21], v[32:33], v[44:45] op_sel_hi:[0,1,1]
    v_pk_fma_f32 v[46:47], v[20:21], v[34:35], v[46:47] op_sel_hi:[0,1,1]
    v_pk_fma_f32 v[44:45], v[22:23], v[36:37], v[44:45] op_sel_hi:[0,1,1]
    v_pk_fma_f32 v[46:47], v[22:23], v[38:39], v[46:47] op_sel_hi:[0,1,1]
    buffer_store_dwordx4 v[44:47], v12, s[12:15], s96 offen sc1
    s_mov_b32 exec_lo, 1
    s_mov_b32 exec_hi, 1
    buffer_store_dwordx2 v[40:41], v14, s[12:15], s96 offen offset:1024 sc1
    s_mov_b64 exec, -1
L_h1:
    buffer_load_dwordx2 v[16:17], v6, s[12:15], s87 offen offset:1024 sc1
    s_waitcnt vmcnt(0)
    v_cmp_u_f32 vcc, v16, v17
    s_cbranch_vccz L_ok_128
    s_add_u32 s59, s59, 1
    s_cmp_lt_u32 s59, 65536
    s_cbranch_scc1 L_h1
L_ok_128:
    s_add_u32 s53, s87, 0
    buffer_load_dwordx4 v[32:35], v5, s[12:15], s53 offen sc1
    s_add_u32 s53, s87, 2304
    buffer_load_dwordx4 v[36:39], v5, s[12:15], s53 offen sc1
    s_add_u32 s53, s87, 4608
    buffer_load_dwordx4 v[40:43], v5, s[12:15], s53 offen sc1
    s_add_u32 s53, s87, 6912
    buffer_load_dwordx4 v[44:47], v5, s[12:15], s53 offen sc1
    s_add_u32 s53, s87, 9216
    buffer_load_dwordx4 v[48:51], v5, s[12:15], s53 offen sc1
    s_add_u32 s53, s87, 11520
    buffer_load_dwordx4 v[52:55], v5, s[12:15], s53 offen sc1
    s_add_u32 s53, s87, 13824
    buffer_load_dwordx4 v[56:59], v5, s[12:15], s53 offen sc1
    s_add_u32 s53, s87, 16128
    buffer_load_dwordx4 v[60:63], v5, s[12:15], s53 offen sc1
    v_max_f32_dpp v18, v16, v16 quad_perm:[1,0,3,2] row_mask:0xf bank_mask:0xf
    v_lshrrev_b32 v28, 4, v1
    v_bfe_u32 v30, v1, 2, 2
    v_max_f32_dpp v18, v18, v18 quad_perm:[2,3,0,1] row_mask:0xf bank_mask:0xf
    v_lshl_add_u32 v28, v28, 3, v30
    v_mul_u32_u24 v28, 72, v28
    v_max_f32_dpp v18, v18, v18 row_half_mirror row_mask:0xf bank_mask:0xf
    v_and_b32 v30, 3, v1
    v_lshl_add_u32 v28, v30, 3, v28
    v_max_f32_dpp v18, v18, v18 row_mirror row_mask:0xf bank_mask:0xf
    v_sub_f32 v16, v16, v18
    v_exp_f32 v16, v16
    s_mul_i32 s52, s3, 32
    s_add_u32 s52, s52, 82400
    v_mul_f32 v19, v16, v17
    v_add_u32 v28, s52, v28
    v_and_b32 v29, 1, v1
    v_add_f32_dpp v19, v19, v19 quad_perm:[1,0,3,2] row_mask:0xf bank_mask:0xf
    v_lshlrev_b32 v29, 9, v29
    v_lshrrev_b32 v30, 4, v1
    v_add_f32_dpp v19, v19, v19 quad_perm:[2,3,0,1] row_mask:0xf bank_mask:0xf
    v_lshl_add_u32 v29, v30, 4, v29
    v_mov_b32 v31, 6352
    v_add_f32_dpp v19, v19, v19 row_half_mirror row_mask:0xf bank_mask:0xf
    s_nop 0
    s_nop 0
    v_add_f32_dpp v19, v19, v19 row_mirror row_mask:0xf bank_mask:0xf
    v_rcp_f32 v19, v19
    s_nop 0
    v_mul_f32 v16, v16, v19
    s_nop 1
    v_mov_b32_dpp v20, v16 row_newbcast:0 row_mask:0x3 bank_mask:0xf
    v_mov_b32_dpp v20, v16 row_newbcast:1 row_mask:0xc bank_mask:0xf
    v_mov_b32_dpp v21, v16 row_newbcast:2 row_mask:0x3 bank_mask:0xf
    v_mov_b32_dpp v21, v16 row_newbcast:3 row_mask:0xc bank_mask:0xf
    v_mov_b32_dpp v22, v16 row_newbcast:4 row_mask:0x3 bank_mask:0xf
    v_mov_b32_dpp v22, v16 row_newbcast:5 row_mask:0xc bank_mask:0xf
    v_mov_b32_dpp v23, v16 row_newbcast:6 row_mask:0x3 bank_mask:0xf
    v_mov_b32_dpp v23, v16 row_newbcast:7 row_mask:0xc bank_mask:0xf
    v_mov_b32_dpp v24, v16 row_newbcast:8 row_mask:0x3 bank_mask:0xf
    v_mov_b32_dpp v24, v16 row_newbcast:9 row_mask:0xc bank_mask:0xf
    v_mov_b32_dpp v25, v16 row_newbcast:10 row_mask:0x3 bank_mask:0xf
    v_mov_b32_dpp v25, v16 row_newbcast:11 row_mask:0xc bank_mask:0xf
    v_mov_b32_dpp v26, v16 row_newbcast:12 row_mask:0x3 bank_mask:0xf
    v_mov_b32_dpp v26, v16 row_newbcast:13 row_mask:0xc bank_mask:0xf
    v_mov_b32_dpp v27, v16 row_newbcast:14 row_mask:0x3 bank_mask:0xf
    v_mov_b32_dpp v27, v16 row_newbcast:15 row_mask:0xc bank_mask:0xf
    s_waitcnt vmcnt(7)
    v_pk_mul_f32 v[32:33], v[20:21], v[32:33] op_sel_hi:[0,1]
    v_pk_mul_f32 v[34:35], v[20:21], v[34:35] op_sel_hi:[0,1]
    s_waitcnt vmcnt(6)
    v_pk_fma_f32 v[32:33], v[20:21], v[36:37], v[32:33] op_sel:[1,0,0] op_sel_hi:[1,1,1]
    v_pk_fma_f32 v[34:35], v[20:21], v[38:39], v[34:35] op_sel:[1,0,0] op_sel_hi:[1,1,1]
    s_waitcnt vmcnt(5)
    v_pk_fma_f32 v[32:33], v[22:23], v[40:41], v[32:33] op_sel:[0,0,0] op_sel_hi:[0,1,1]
    v_pk_fma_f32 v[34:35], v[22:23], v[42:43], v[34:35] op_sel:[0,0,0] op_sel_hi:[0,1,1]
    s_waitcnt vmcnt(4)
    v_pk_fma_f32 v[32:33], v[22:23], v[44:45], v[32:33] op_sel:[1,0,0] op_sel_hi:[1,1,1]
    v_pk_fma_f32 v[34:35], v[22:23], v[46:47], v[34:35] op_sel:[1,0,0] op_sel_hi:[1,1,1]
    s_waitcnt vmcnt(3)
    v_pk_fma_f32 v[32:33], v[24:25], v[48:49], v[32:33] op_sel:[0,0,0] op_sel_hi:[0,1,1]
    v_pk_fma_f32 v[34:35], v[24:25], v[50:51], v[34:35] op_sel:[0,0,0] op_sel_hi:[0,1,1]
    s_waitcnt vmcnt(2)
    v_pk_fma_f32 v[32:33], v[24:25], v[52:53], v[32:33] op_sel:[1,0,0] op_sel_hi:[1,1,1]
    v_pk_fma_f32 v[34:35], v[24:25], v[54:55], v[34:35] op_sel:[1,0,0] op_sel_hi:[1,1,1]
    s_waitcnt vmcnt(1)
    v_pk_fma_f32 v[32:33], v[26:27], v[56:57], v[32:33] op_sel:[0,0,0] op_sel_hi:[0,1,1]
    v_pk_fma_f32 v[34:35], v[26:27], v[58:59], v[34:35] op_sel:[0,0,0] op_sel_hi:[0,1,1]
    s_waitcnt vmcnt(0)
    v_pk_fma_f32 v[32:33], v[26:27], v[60:61], v[32:33] op_sel:[1,0,0] op_sel_hi:[1,1,1]
    v_pk_fma_f32 v[34:35], v[26:27], v[62:63], v[34:35] op_sel:[1,0,0] op_sel_hi:[1,1,1]
    v_mov_b32 v36, v32
    v_mov_b32 v37, v33
    v_mov_b32 v38, v34
    v_mov_b32 v39, v35
    v_permlane32_swap_b32 v32, v36
    v_permlane32_swap_b32 v33, v37
    v_permlane32_swap_b32 v34, v38
    v_permlane32_swap_b32 v35, v39
    v_pk_add_f32 v[32:33], v[32:33], v[36:37]
    v_pk_add_f32 v[34:35], v[34:35], v[38:39]
    v_add_f32 v36, v32, v33
    v_add_f32 v37, v34, v35
    v_cvt_pk_bf16_f32 v32, v32, v33
    v_cvt_pk_bf16_f32 v33, v34, v35
    v_cmp_u_f32 vcc, v36, v37
    s_cbranch_vccz L_ok_129
    s_add_u32 s59, s59, 1
    s_cmp_lt_u32 s59, 65536
    s_cbranch_scc1 L_h1
L_ok_129:
    ds_write_b64 v7, v[32:33] offset:5312
    s_cmp_eq_u32 s3, 3
    s_cbranch_scc1 L_w3_a
    v_mov_b32 v5, v28
    v_mov_b32 v6, v29
    ds_read_b32 v14, v31 offset:4
    ds_read_b64_tr_b16 v[36:37], v5 offset:0
    ds_read_b64_tr_b16 v[38:39], v5 offset:288
    ds_read_b64_tr_b16 v[40:41], v5 offset:2304
    ds_read_b64_tr_b16 v[42:43], v5 offset:2592
    ds_read_b64_tr_b16 v[44:45], v5 offset:4608
    ds_read_b64_tr_b16 v[46:47], v5 offset:4896
    ds_read_b64_tr_b16 v[48:49], v5 offset:6912
    ds_read_b64_tr_b16 v[50:51], v5 offset:7200
    ds_read_b64_tr_b16 v[52:53], v5 offset:9216
    ds_read_b64_tr_b16 v[54:55], v5 offset:9504
    ds_read_b64_tr_b16 v[56:57], v5 offset:11520
    ds_read_b64_tr_b16 v[58:59], v5 offset:11808
    ds_read_b64_tr_b16 v[60:61], v5 offset:13824
    ds_read_b64_tr_b16 v[62:63], v5 offset:14112
    s_waitcnt lgkmcnt(14)
    v_readfirstlane_b32 s74, v14
    s_barrier
    ds_read_b128 v[16:19], v6 offset:5312
    ds_read_b128 v[20:23], v6 offset:5376
    ds_read_b128 v[24:27], v6 offset:5440
    ds_read_b128 v[28:31], v6 offset:5504
    ds_read_b128 v[32:35], v6 offset:5568
    s_waitcnt lgkmcnt(4)
    v_mfma_f32_16x16x32_bf16 v[12:15], v[36:39], v[16:19], 0
    ds_read_b128 v[36:39], v6 offset:5632
    ds_read_b128 v[16:19], v6 offset:5696
    s_waitcnt lgkmcnt(5)
    v_mfma_f32_16x16x32_bf16 v[12:15], v[40:43], v[20:23], v[12:15]
    ds_read_b128 v[40:43], v6 offset:5760
    ds_read_b64_tr_b16 v[20:21], v5 offset:16128
    ds_read_b64_tr_b16 v[22:23], v5 offset:16416
    s_waitcnt lgkmcnt(7)
    v_mfma_f32_16x16x32_bf16 v[12:15], v[44:47], v[24:27], v[12:15]
    s_waitcnt lgkmcnt(6)
    v_mfma_f32_16x16x32_bf16 v[12:15], v[48:51], v[28:31], v[12:15]
    s_waitcnt lgkmcnt(5)
    v_mfma_f32_16x16x32_bf16 v[12:15], v[52:55], v[32:35], v[12:15]
    s_waitcnt lgkmcnt(4)
    v_mfma_f32_16x16x32_bf16 v[12:15], v[56:59], v[36:39], v[12:15]
    s_waitcnt lgkmcnt(3)
    v_mfma_f32_16x16x32_bf16 v[12:15], v[60:63], v[16:19], v[12:15]
    s_waitcnt lgkmcnt(0)
    v_mfma_f32_16x16x32_bf16 v[12:15], v[20:23], v[40:43], v[12:15]
    v_lshrrev_b32 v16, 1, v1
    v_mul_u32_u24 v7, 12, v1
    s_mul_i32 s52, s3, 768
    v_add_u32 v7, s52, v7
    s_nop 3
    v_add_f32_dpp v12, v14, v12 quad_perm:[1,1,1,1] row_mask:0xf bank_mask:0xf
    v_add_f32_dpp v13, v15, v13 quad_perm:[1,1,1,1] row_mask:0xf bank_mask:0xf
    s_mov_b64 exec, s[70:71]
    buffer_store_dwordx2 v[12:13], v16, s[12:15], s84 offen sc1
    s_mov_b64 exec, -1
    v_lshrrev_b32 v5, 4, v1
    v_bfe_u32 v48, v1, 2, 2
    v_lshl_add_u32 v5, v5, 3, v48
    v_mul_u32_u24 v5, 72, v5
    v_and_b32 v48, 3, v1
    v_lshl_add_u32 v5, v48, 3, v5
    s_mul_i32 s52, s3, 32
    s_add_u32 s52, s52, 100832
    v_add_u32 v5, s52, v5
    v_lshrrev_b32 v6, 4, v1
    v_lshlrev_b32 v6, 4, v6
    ds_read_b64_tr_b16 v[48:49], v5 offset:0
    ds_read_b64_tr_b16 v[50:51], v5 offset:288
    ds_read_b64_tr_b16 v[52:53], v5 offset:2304
    ds_read_b64_tr_b16 v[54:55], v5 offset:2592
    ds_read_b64_tr_b16 v[56:57], v5 offset:4608
    ds_read_b64_tr_b16 v[58:59], v5 offset:4896
    ds_read_b64_tr_b16 v[60:61], v5 offset:6912
    ds_read_b64_tr_b16 v[62:63], v5 offset:7200
    s_waitcnt vmcnt(0)
    s_sleep 12
    s_mov_b32 s59, 0
L_h2:
    s_mov_b32 s53, 327680
    buffer_load_dwordx3 v[16:18], v7, s[12:15], s53 offen sc1
    s_mov_b32 s53, 329984
    buffer_load_dwordx3 v[20:22], v7, s[12:15], s53 offen sc1
    s_mov_b32 s53, 332288
    buffer_load_dwordx3 v[24:26], v7, s[12:15], s53 offen sc1
    s_mov_b32 s53, 334592
    buffer_load_dwordx3 v[28:30], v7, s[12:15], s53 offen sc1
    s_mov_b32 s53, 336896
    buffer_load_dwordx3 v[32:34], v7, s[12:15], s53 offen sc1
    s_mov_b32 s53, 339200
    buffer_load_dwordx3 v[36:38], v7, s[12:15], s53 offen sc1
    s_mov_b32 s53, 341504
    buffer_load_dwordx3 v[40:42], v7, s[12:15], s53 offen sc1
    s_mov_b32 s53, 343808
    buffer_load_dwordx3 v[44:46], v7, s[12:15], s53 offen sc1
    s_waitcnt vmcnt(6)
    v_pk_add_f32 v[16:17], v[16:17], v[20:21]
    v_add_f32 v18, v18, v22
    s_waitcnt vmcnt(5)
    v_pk_add_f32 v[16:17], v[16:17], v[24:25]
    v_add_f32 v18, v18, v26
    s_waitcnt vmcnt(4)
    v_pk_add_f32 v[16:17], v[16:17], v[28:29]
    v_add_f32 v18, v18, v30
    s_waitcnt vmcnt(3)
    v_pk_add_f32 v[16:17], v[16:17], v[32:33]
    v_add_f32 v18, v18, v34
    s_waitcnt vmcnt(2)
    v_pk_add_f32 v[16:17], v[16:17], v[36:37]
    v_add_f32 v18, v18, v38
    s_waitcnt vmcnt(1)
    v_pk_add_f32 v[16:17], v[16:17], v[40:41]
    v_add_f32 v18, v18, v42
    s_waitcnt vmcnt(0)
    v_pk_add_f32 v[16:17], v[16:17], v[44:45]
    v_add_f32 v18, v18, v46
    v_add_f32 v19, v16, v17
    v_cvt_pk_bf16_f32 v20, 0, v16
    v_cvt_pk_bf16_f32 v21, 0, v17
    v_cvt_pk_bf16_f32 v22, 0, v18
    v_cmp_u_f32 vcc, v19, v18
    s_cbranch_vccz L_ok_130
    s_add_u32 s59, s59, 1
    s_cmp_lt_u32 s59, 65536
    s_cbranch_scc1 L_h2
L_ok_130:
    v_add_f32 v8, v8, v20
    v_add_f32 v9, v9, v21
    v_add_f32 v10, v10, v22
    v_cvt_pk_bf16_f32 v8, 0, v8
    v_cvt_pk_bf16_f32 v9, 0, v9
    v_cvt_pk_bf16_f32 v10, 0, v10
    v_lshrrev_b32 v19, 1, v7
    ds_write_b16_d16_hi v19, v8 offset:4160
    ds_write_b16_d16_hi v19, v9 offset:4162
    ds_write_b16_d16_hi v19, v10 offset:4164
    ds_read_b64_tr_b16 v[32:33], v5 offset:9216
    ds_read_b64_tr_b16 v[34:35], v5 offset:9504
    ds_read_b64_tr_b16 v[36:37], v5 offset:11520
    ds_read_b64_tr_b16 v[38:39], v5 offset:11808
    ds_read_b64_tr_b16 v[40:41], v5 offset:13824
    ds_read_b64_tr_b16 v[42:43], v5 offset:14112
    ds_read_b64_tr_b16 v[44:45], v5 offset:16128
    ds_read_b64_tr_b16 v[46:47], v5 offset:16416
    s_waitcnt lgkmcnt(8)
    s_barrier
    ds_read_b128 v[16:19], v6 offset:4160
    ds_read_b128 v[20:23], v6 offset:4224
    ds_read_b128 v[24:27], v6 offset:4288
    ds_read_b128 v[28:31], v6 offset:4352
    s_waitcnt lgkmcnt(3)
    v_mfma_f32_16x16x32_bf16 v[12:15], v[48:51], v[16:19], 0
    ds_read_b128 v[48:51], v6 offset:4416
    ds_read_b128 v[16:19], v6 offset:4480
    s_waitcnt lgkmcnt(4)
    v_mfma_f32_16x16x32_bf16 v[12:15], v[52:55], v[20:23], v[12:15]
    ds_read_b128 v[52:55], v6 offset:4544
    ds_read_b128 v[20:23], v6 offset:4608
    s_waitcnt lgkmcnt(5)
    v_mfma_f32_16x16x32_bf16 v[12:15], v[56:59], v[24:27], v[12:15]
    ds_read_b128 v[56:59], v6 offset:4672
    ds_read_b64_tr_b16 v[24:25], v5 offset:18432
    ds_read_b64_tr_b16 v[26:27], v5 offset:18720
    s_waitcnt lgkmcnt(7)
    v_mfma_f32_16x16x32_bf16 v[12:15], v[60:63], v[28:31], v[12:15]
    ds_read_b128 v[60:63], v6 offset:4736
    ds_read_b64_tr_b16 v[28:29], v5 offset:20736
    ds_read_b64_tr_b16 v[30:31], v5 offset:21024
    s_waitcnt lgkmcnt(9)
    v_mfma_f32_16x16x32_bf16 v[12:15], v[32:35], v[48:51], v[12:15]
    ds_read_b128 v[32:35], v6 offset:4800
    ds_read_b64_tr_b16 v[48:49], v5 offset:23040
    ds_read_b64_tr_b16 v[50:51], v5 offset:23328
    s_waitcnt lgkmcnt(11)
    v_mfma_f32_16x16x32_bf16 v[12:15], v[36:39], v[16:19], v[12:15]
    ds_read_b128 v[36:39], v6 offset:4864
    ds_read_b64_tr_b16 v[16:17], v5 offset:25344
    ds_read_b64_tr_b16 v[18:19], v5 offset:25632
    s_waitcnt lgkmcnt(13)
    v_mfma_f32_16x16x32_bf16 v[12:15], v[40:43], v[52:55], v[12:15]
    ds_read_b128 v[40:43], v6 offset:4928
    ds_read_b64_tr_b16 v[52:53], v5 offset:27648
    ds_read_b64_tr_b16 v[54:55], v5 offset:27936
    s_waitcnt lgkmcnt(15)
    v_mfma_f32_16x16x32_bf16 v[12:15], v[44:47], v[20:23], v[12:15]
    ds_read_b128 v[44:47], v6 offset:4992
    ds_read_b64_tr_b16 v[20:21], v5 offset:29952
    ds_read_b64_tr_b16 v[22:23], v5 offset:30240
    s_waitcnt lgkmcnt(15)
    v_mfma_f32_16x16x32_bf16 v[12:15], v[24:27], v[56:59], v[12:15]
    ds_read_b128 v[24:27], v6 offset:5056
    ds_read_b64_tr_b16 v[56:57], v5 offset:32256
    ds_read_b64_tr_b16 v[58:59], v5 offset:32544
    s_waitcnt lgkmcnt(15)
    v_mfma_f32_16x16x32_bf16 v[12:15], v[28:31], v[60:63], v[12:15]
    ds_read_b128 v[28:31], v6 offset:5120
    ds_read_b64_tr_b16 v[60:61], v5 offset:34560
    ds_read_b64_tr_b16 v[62:63], v5 offset:34848
    s_waitcnt lgkmcnt(15)
    v_mfma_f32_16x16x32_bf16 v[12:15], v[48:51], v[32:35], v[12:15]
    ds_read_b128 v[48:51], v6 offset:5184
    ds_read_b64_tr_b16 v[32:33], v5 offset:36864
    ds_read_b64_tr_b16 v[34:35], v5 offset:37152
    s_waitcnt lgkmcnt(15)
    v_mfma_f32_16x16x32_bf16 v[12:15], v[16:19], v[36:39], v[12:15]
    ds_read_b128 v[16:19], v6 offset:5248
    ds_read_b64_tr_b16 v[36:37], v5 offset:39168
    ds_read_b64_tr_b16 v[38:39], v5 offset:39456
    s_waitcnt lgkmcnt(15)
    v_mfma_f32_16x16x32_bf16 v[12:15], v[52:55], v[40:43], v[12:15]
    s_waitcnt lgkmcnt(12)
    v_mfma_f32_16x16x32_bf16 v[12:15], v[20:23], v[44:47], v[12:15]
    s_waitcnt lgkmcnt(9)
    v_mfma_f32_16x16x32_bf16 v[12:15], v[56:59], v[24:27], v[12:15]
    s_waitcnt lgkmcnt(6)
    v_mfma_f32_16x16x32_bf16 v[12:15], v[60:63], v[28:31], v[12:15]
    s_waitcnt lgkmcnt(3)
    v_mfma_f32_16x16x32_bf16 v[12:15], v[32:35], v[48:51], v[12:15]
    s_waitcnt lgkmcnt(0)
    v_mfma_f32_16x16x32_bf16 v[12:15], v[36:39], v[16:19], v[12:15]
    s_lshl_b32 s52, s3, 6
    v_add_u32 v22, s52, v6
    ds_read_b128 v[16:19], v22 offset:6368
    v_lshrrev_b32 v23, 2, v1
    s_barrier
    v_mov_b32 v22, 6336
    ds_read_b64 v[20:21], v22
    s_waitcnt lgkmcnt(0)
    v_fma_f32 v12, -v20, v16, v12
    v_fma_f32 v13, -v20, v17, v13
    v_fma_f32 v14, -v20, v18, v14
    v_fma_f32 v15, -v20, v19, v15
    v_mul_f32 v12, v12, v21
    v_mul_f32 v13, v13, v21
    v_mul_f32 v14, v14, v21
    v_mul_f32 v15, v15, v21
    v_cvt_pk_bf16_f32 v12, 0, v12
    v_cvt_pk_bf16_f32 v13, 0, v13
    v_cvt_pk_bf16_f32 v14, 0, v14
    v_cvt_pk_bf16_f32 v15, 0, v15
    v_max_f32 v12, 0, v12
    v_max_f32 v13, 0, v13
    v_mul_f32 v12, v12, v14
    v_mul_f32 v13, v13, v15
    v_cvt_pk_bf16_f32 v12, v12, v13
    s_mov_b64 exec, s[70:71]
    s_cmp_eq_u32 s74, 1
    s_cbranch_scc1 L_hs_131
    buffer_store_dword v12, v23, s[12:15], s85 offen sc1
    s_waitcnt vmcnt(0)
    s_sleep 6
    s_branch L_hs_132
L_hs_131:
    buffer_store_dword v12, v23, s[12:15], s85 offen
L_hs_132:
    s_mov_b64 exec, -1
    v_lshrrev_b32 v5, 4, v1
    v_bfe_u32 v52, v1, 2, 2
    v_lshl_add_u32 v5, v5, 3, v52
    v_mul_u32_u24 v5, 72, v5
    v_and_b32 v52, 3, v1
    v_lshl_add_u32 v5, v52, 3, v5
    s_mul_i32 s52, s3, 32
    s_add_u32 s52, s52, 142304
    v_add_u32 v5, s52, v5
    v_and_b32 v52, 1, v1
    v_mul_u32_u24 v52, 576, v52
    v_add_u32 v6, v6, v52
    s_mov_b32 s59, 0
    s_waitcnt vmcnt(0)
L_h3:
    s_mov_b32 exec_lo, 0x00030003
    s_mov_b32 exec_hi, 0x00030003
    buffer_load_dwordx4 v[16:19], v6, s[12:15], s91 offen offset:0 sc1
    buffer_load_dwordx4 v[20:23], v6, s[12:15], s91 offen offset:64 sc1
    buffer_load_dwordx4 v[24:27], v6, s[12:15], s91 offen offset:128 sc1
    buffer_load_dwordx4 v[28:31], v6, s[12:15], s91 offen offset:192 sc1
    buffer_load_dwordx4 v[32:35], v6, s[12:15], s91 offen offset:256 sc1
    buffer_load_dwordx4 v[36:39], v6, s[12:15], s91 offen offset:320 sc1
    buffer_load_dwordx4 v[40:43], v6, s[12:15], s91 offen offset:384 sc1
    buffer_load_dwordx4 v[44:47], v6, s[12:15], s91 offen offset:448 sc1
    buffer_load_dwordx4 v[48:51], v6, s[12:15], s91 offen offset:512 sc1
    s_mov_b64 exec, -1
    ds_read_b64_tr_b16 v[52:53], v5 offset:0
    ds_read_b64_tr_b16 v[54:55], v5 offset:288
    ds_read_b64_tr_b16 v[56:57], v5 offset:2304
    ds_read_b64_tr_b16 v[58:59], v5 offset:2592
    ds_read_b64_tr_b16 v[60:61], v5 offset:4608
    ds_read_b64_tr_b16 v[62:63], v5 offset:4896
    s_waitcnt vmcnt(0)
    s_waitcnt lgkmcnt(4)
    v_mfma_f32_16x16x32_bf16 v[12:15], v[52:55], v[16:19], 0
    ds_read_b64_tr_b16 v[52:53], v5 offset:6912
    ds_read_b64_tr_b16 v[54:55], v5 offset:7200
    ds_read_b64_tr_b16 v[16:17], v5 offset:9216
    ds_read_b64_tr_b16 v[18:19], v5 offset:9504
    s_waitcnt lgkmcnt(6)
    v_mfma_f32_16x16x32_bf16 v[12:15], v[56:59], v[20:23], v[12:15]
    ds_read_b64_tr_b16 v[56:57], v5 offset:11520
    ds_read_b64_tr_b16 v[58:59], v5 offset:11808
    ds_read_b64_tr_b16 v[20:21], v5 offset:13824
    ds_read_b64_tr_b16 v[22:23], v5 offset:14112
    s_waitcnt lgkmcnt(8)
    v_mfma_f32_16x16x32_bf16 v[12:15], v[60:63], v[24:27], v[12:15]
    ds_read_b64_tr_b16 v[60:61], v5 offset:16128
    ds_read_b64_tr_b16 v[62:63], v5 offset:16416
    ds_read_b64_tr_b16 v[24:25], v5 offset:18432
    ds_read_b64_tr_b16 v[26:27], v5 offset:18720
    s_waitcnt lgkmcnt(10)
    v_mfma_f32_16x16x32_bf16 v[12:15], v[52:55], v[28:31], v[12:15]
    s_waitcnt lgkmcnt(8)
    v_mfma_f32_16x16x32_bf16 v[12:15], v[16:19], v[32:35], v[12:15]
    s_waitcnt lgkmcnt(6)
    v_mfma_f32_16x16x32_bf16 v[12:15], v[56:59], v[36:39], v[12:15]
    s_waitcnt lgkmcnt(4)
    v_mfma_f32_16x16x32_bf16 v[12:15], v[20:23], v[40:43], v[12:15]
    s_waitcnt lgkmcnt(2)
    v_mfma_f32_16x16x32_bf16 v[12:15], v[60:63], v[44:47], v[12:15]
    s_waitcnt lgkmcnt(0)
    v_mfma_f32_16x16x32_bf16 v[12:15], v[24:27], v[48:51], v[12:15]
    v_lshrrev_b32 v16, 1, v1
    v_mul_u32_u24 v7, 12, v1
    s_mul_i32 s52, s3, 768
    v_add_u32 v7, s52, v7
    s_nop 3
    v_add_f32_dpp v12, v14, v12 quad_perm:[1,1,1,1] row_mask:0xf bank_mask:0xf
    v_add_f32_dpp v13, v15, v13 quad_perm:[1,1,1,1] row_mask:0xf bank_mask:0xf
    s_mov_b64 exec, s[70:71]
    v_cmp_u_f32 vcc, v12, v13
    s_mov_b64 exec, -1
    s_cbranch_vccz L_ok_133
    s_add_u32 s59, s59, 1
    s_cmp_lt_u32 s59, 65536
    s_cbranch_scc1 L_h3
L_ok_133:
    s_mov_b64 exec, s[70:71]
    buffer_store_dwordx2 v[12:13], v16, s[12:15], s86 offen sc1
    s_mov_b64 exec, -1
    s_cmp_eq_u32 s50, 1
    s_cbranch_scc1 L_final
    v_lshrrev_b32 v5, 4, v1
    v_bfe_u32 v48, v1, 2, 2
    v_lshl_add_u32 v5, v5, 3, v48
    v_mul_u32_u24 v5, 32, v5
    v_and_b32 v48, 3, v1
    v_lshl_add_u32 v5, v48, 3, v5
    v_add_u32 v5, 6624, v5
    v_lshrrev_b32 v6, 4, v1
    v_lshlrev_b32 v6, 4, v6
    ds_read_b64_tr_b16 v[48:49], v5 offset:0
    ds_read_b64_tr_b16 v[50:51], v5 offset:128
    ds_read_b64_tr_b16 v[52:53], v5 offset:1024
    ds_read_b64_tr_b16 v[54:55], v5 offset:1152
    ds_read_b64_tr_b16 v[56:57], v5 offset:2048
    ds_read_b64_tr_b16 v[58:59], v5 offset:2176
    ds_read_b64_tr_b16 v[60:61], v5 offset:3072
    ds_read_b64_tr_b16 v[62:63], v5 offset:3200
    s_waitcnt vmcnt(0)
    s_sleep 12
    s_mov_b32 s59, 0
L_h4:
    s_mov_b32 s53, 393216
    buffer_load_dwordx3 v[16:18], v7, s[12:15], s53 offen sc1
    s_mov_b32 s53, 395520
    buffer_load_dwordx3 v[20:22], v7, s[12:15], s53 offen sc1
    s_mov_b32 s53, 397824
    buffer_load_dwordx3 v[24:26], v7, s[12:15], s53 offen sc1
    s_mov_b32 s53, 400128
    buffer_load_dwordx3 v[28:30], v7, s[12:15], s53 offen sc1
    s_mov_b32 s53, 402432
    buffer_load_dwordx3 v[32:34], v7, s[12:15], s53 offen sc1
    s_mov_b32 s53, 404736
    buffer_load_dwordx3 v[36:38], v7, s[12:15], s53 offen sc1
    s_mov_b32 s53, 407040
    buffer_load_dwordx3 v[40:42], v7, s[12:15], s53 offen sc1
    s_mov_b32 s53, 409344
    buffer_load_dwordx3 v[44:46], v7, s[12:15], s53 offen sc1
    s_waitcnt vmcnt(6)
    v_pk_add_f32 v[16:17], v[16:17], v[20:21]
    v_add_f32 v18, v18, v22
    s_waitcnt vmcnt(5)
    v_pk_add_f32 v[16:17], v[16:17], v[24:25]
    v_add_f32 v18, v18, v26
    s_waitcnt vmcnt(4)
    v_pk_add_f32 v[16:17], v[16:17], v[28:29]
    v_add_f32 v18, v18, v30
    s_waitcnt vmcnt(3)
    v_pk_add_f32 v[16:17], v[16:17], v[32:33]
    v_add_f32 v18, v18, v34
    s_waitcnt vmcnt(2)
    v_pk_add_f32 v[16:17], v[16:17], v[36:37]
    v_add_f32 v18, v18, v38
    s_waitcnt vmcnt(1)
    v_pk_add_f32 v[16:17], v[16:17], v[40:41]
    v_add_f32 v18, v18, v42
    s_waitcnt vmcnt(0)
    v_pk_add_f32 v[16:17], v[16:17], v[44:45]
    v_add_f32 v18, v18, v46
    v_add_f32 v19, v16, v17
    v_cvt_pk_bf16_f32 v20, 0, v16
    v_cvt_pk_bf16_f32 v21, 0, v17
    v_cvt_pk_bf16_f32 v22, 0, v18
    v_cmp_u_f32 vcc, v19, v18
    s_cbranch_vccz L_ok_134
    s_add_u32 s59, s59, 1
    s_cmp_lt_u32 s59, 65536
    s_cbranch_scc1 L_h4
L_ok_134:
    v_add_f32 v8, v8, v20
    v_add_f32 v9, v9, v21
    v_add_f32 v10, v10, v22
    v_cvt_pk_bf16_f32 v8, 0, v8
    v_cvt_pk_bf16_f32 v9, 0, v9
    v_cvt_pk_bf16_f32 v10, 0, v10
    v_lshrrev_b32 v19, 1, v7
    ds_write_b16_d16_hi v19, v8 offset:4160
    ds_write_b16_d16_hi v19, v9 offset:4162
    ds_write_b16_d16_hi v19, v10 offset:4164
    ds_read_b64_tr_b16 v[32:33], v5 offset:4096
    ds_read_b64_tr_b16 v[34:35], v5 offset:4224
    ds_read_b64_tr_b16 v[36:37], v5 offset:5120
    ds_read_b64_tr_b16 v[38:39], v5 offset:5248
    ds_read_b64_tr_b16 v[40:41], v5 offset:6144
    ds_read_b64_tr_b16 v[42:43], v5 offset:6272
    ds_read_b64_tr_b16 v[44:45], v5 offset:7168
    ds_read_b64_tr_b16 v[46:47], v5 offset:7296
    s_waitcnt lgkmcnt(8)
    s_barrier
    s_cmp_lg_u32 s3, 0
    s_cbranch_scc1 L_b10
    ds_read_b128 v[16:19], v6 offset:4160
    ds_read_b128 v[20:23], v6 offset:4224
    ds_read_b128 v[24:27], v6 offset:4288
    ds_read_b128 v[28:31], v6 offset:4352
    s_waitcnt lgkmcnt(3)
    v_mfma_f32_16x16x32_bf16 v[12:15], v[48:51], v[16:19], 0
    ds_read_b128 v[48:51], v6 offset:4416
    ds_read_b128 v[16:19], v6 offset:4480
    s_waitcnt lgkmcnt(4)
    v_mfma_f32_16x16x32_bf16 v[12:15], v[52:55], v[20:23], v[12:15]
    ds_read_b128 v[52:55], v6 offset:4544
    ds_read_b128 v[20:23], v6 offset:4608
    s_waitcnt lgkmcnt(5)
    v_mfma_f32_16x16x32_bf16 v[12:15], v[56:59], v[24:27], v[12:15]
    ds_read_b128 v[56:59], v6 offset:4672
    ds_read_b64_tr_b16 v[24:25], v5 offset:8192
    ds_read_b64_tr_b16 v[26:27], v5 offset:8320
    s_waitcnt lgkmcnt(7)
    v_mfma_f32_16x16x32_bf16 v[12:15], v[60:63], v[28:31], v[12:15]
    ds_read_b128 v[60:63], v6 offset:4736
    ds_read_b64_tr_b16 v[28:29], v5 offset:9216
    ds_read_b64_tr_b16 v[30:31], v5 offset:9344
    s_waitcnt lgkmcnt(9)
    v_mfma_f32_16x16x32_bf16 v[12:15], v[32:35], v[48:51], v[12:15]
    ds_read_b128 v[32:35], v6 offset:4800
    ds_read_b64_tr_b16 v[48:49], v5 offset:10240
    ds_read_b64_tr_b16 v[50:51], v5 offset:10368
    s_waitcnt lgkmcnt(11)
    v_mfma_f32_16x16x32_bf16 v[12:15], v[36:39], v[16:19], v[12:15]
    ds_read_b128 v[36:39], v6 offset:4864
    ds_read_b64_tr_b16 v[16:17], v5 offset:11264
    ds_read_b64_tr_b16 v[18:19], v5 offset:11392
    s_waitcnt lgkmcnt(13)
    v_mfma_f32_16x16x32_bf16 v[12:15], v[40:43], v[52:55], v[12:15]
    ds_read_b128 v[40:43], v6 offset:4928
    ds_read_b64_tr_b16 v[52:53], v5 offset:12288
    ds_read_b64_tr_b16 v[54:55], v5 offset:12416
    s_waitcnt lgkmcnt(15)
    v_mfma_f32_16x16x32_bf16 v[12:15], v[44:47], v[20:23], v[12:15]
    ds_read_b128 v[44:47], v6 offset:4992
    ds_read_b64_tr_b16 v[20:21], v5 offset:13312
    ds_read_b64_tr_b16 v[22:23], v5 offset:13440
    s_waitcnt lgkmcnt(15)
    v_mfma_f32_16x16x32_bf16 v[12:15], v[24:27], v[56:59], v[12:15]
    ds_read_b128 v[24:27], v6 offset:5056
    ds_read_b64_tr_b16 v[56:57], v5 offset:14336
    ds_read_b64_tr_b16 v[58:59], v5 offset:14464
    s_waitcnt lgkmcnt(15)
    v_mfma_f32_16x16x32_bf16 v[12:15], v[28:31], v[60:63], v[12:15]
    ds_read_b128 v[28:31], v6 offset:5120
    ds_read_b64_tr_b16 v[60:61], v5 offset:15360
    ds_read_b64_tr_b16 v[62:63], v5 offset:15488
    s_waitcnt lgkmcnt(15)
    v_mfma_f32_16x16x32_bf16 v[12:15], v[48:51], v[32:35], v[12:15]
    ds_read_b128 v[48:51], v6 offset:5184
    ds_read_b64_tr_b16 v[32:33], v5 offset:16384
    ds_read_b64_tr_b16 v[34:35], v5 offset:16512
    s_waitcnt lgkmcnt(15)
    v_mfma_f32_16x16x32_bf16 v[12:15], v[16:19], v[36:39], v[12:15]
    ds_read_b128 v[16:19], v6 offset:5248
    ds_read_b64_tr_b16 v[36:37], v5 offset:17408
    ds_read_b64_tr_b16 v[38:39], v5 offset:17536
    s_waitcnt lgkmcnt(15)
    v_mfma_f32_16x16x32_bf16 v[12:15], v[52:55], v[40:43], v[12:15]
    s_waitcnt lgkmcnt(12)
    v_mfma_f32_16x16x32_bf16 v[12:15], v[20:23], v[44:47], v[12:15]
    s_waitcnt lgkmcnt(9)
    v_mfma_f32_16x16x32_bf16 v[12:15], v[56:59], v[24:27], v[12:15]
    s_waitcnt lgkmcnt(6)
    v_mfma_f32_16x16x32_bf16 v[12:15], v[60:63], v[28:31], v[12:15]
    s_waitcnt lgkmcnt(3)
    v_mfma_f32_16x16x32_bf16 v[12:15], v[32:35], v[48:51], v[12:15]
    s_waitcnt lgkmcnt(0)
    v_mfma_f32_16x16x32_bf16 v[12:15], v[36:39], v[16:19], v[12:15]
    ds_read_b128 v[16:19], v6 offset:6560
    v_lshrrev_b32 v23, 1, v1
    s_add_u32 s52, s92, 425984
    s_nop 0
    s_barrier
    v_mov_b32 v22, 6336
    ds_read_b64 v[20:21], v22
    s_waitcnt lgkmcnt(0)
    v_fma_f32 v12, -v20, v16, v12
    v_fma_f32 v13, -v20, v17, v13
    v_fma_f32 v14, -v20, v18, v14
    v_fma_f32 v15, -v20, v19, v15
    v_mul_f32 v12, v12, v21
    v_mul_f32 v13, v13, v21
    v_mul_f32 v14, v14, v21
    v_mul_f32 v15, v15, v21
    v_cvt_pk_bf16_f32 v12, v12, v13
    v_cvt_pk_bf16_f32 v13, v14, v15
    s_mov_b64 exec, s[70:71]
    buffer_store_dwordx2 v[12:13], v23, s[12:15], s52 offen sc1
    s_mov_b64 exec, -1
    v_and_b32 v5, 1, v1
    v_lshlrev_b32 v5, 8, v5
    v_lshrrev_b32 v6, 2, v1
    v_lshl_add_u32 v5, v6, 4, v5
    s_waitcnt vmcnt(0)
    s_barrier
    s_branch L_b11x
L_b10:
    s_waitcnt lgkmcnt(0)
    s_barrier
L_b11:
    v_and_b32 v5, 1, v1
    v_lshlrev_b32 v5, 8, v5
    v_lshrrev_b32 v6, 2, v1
    v_lshl_add_u32 v5, v6, 4, v5
    s_barrier
L_b11x:
    s_add_u32 s52, s93, 425984
    s_mov_b32 s59, 0
L_h5:
    buffer_load_dwordx4 v[20:23], v5, s[12:15], s52 offen sc1
    s_mov_b32 s55, s52
    s_mov_b32 s69, 30
    s_mov_b32 s65, 704
    s_mov_b32 s66, 491520
    s_mov_b32 s67, 0
    s_mov_b32 s57, 0
    s_mov_b32 s88, 0
    s_mov_b32 s60, 1
    s_mov_b32 s89, s90
    s_mov_b32 s68, 16384
    s_mov_b32 s75, s101
    s_mov_b32 s56, 2
    v_mov_b32 v12, 0xff167699
    v_mul_f32 v13, s51, v12
    v_mov_b32 v14, 0
    v_mov_b32 v16, 0
    v_mov_b32 v17, 0
    v_mov_b32 v18, 0
    v_mov_b32 v19, 0
    v_mov_b32 v40, 0
    v_mov_b32 v41, 0
    v_mov_b32 v42, 0
    v_mov_b32 v43, 0
    v_mov_b32 v44, 0
    v_mov_b32 v45, 0
    v_mov_b32 v46, 0
    v_mov_b32 v47, 0
    s_mov_b32 s52, s55
    s_waitcnt vmcnt(0)
    v_max3_u32 v24, v20, v21, v22
    v_max_u32 v24, v24, v23
    v_cmp_eq_u32 vcc, -1, v24
    s_cbranch_vccz L_ok_135
    s_add_u32 s59, s59, 1
    s_cmp_lt_u32 s59, 65536
    s_cbranch_scc1 L_h5
L_ok_135:
    s_mov_b32 s50, 1
    s_add_u32 s12, s12, 1048576
    s_addc_u32 s13, s13, 0
    s_mov_b32 s14, 7340032
    s_add_u32 s82, s82, 128
    s_addc_u32 s83, s83, 0
    s_branch L_layer
L_w3_a:
    v_mov_b32 v13, 6352
    ds_read_b32 v14, v13 offset:4
    s_waitcnt lgkmcnt(0)
    s_barrier
    v_readfirstlane_b32 s74, v14
    v_lshlrev_b32 v58, 7, v1
    s_cmp_lg_u32 s74, 1
    s_cbranch_scc1 L_pt_136
    s_mov_b64 exec, 0x1ff
    buffer_load_dword v59, v58, s[12:15], s91 offen sc1
    s_mov_b64 exec, -1
L_pt_136:
    s_cmp_lg_u32 s50, 0
    s_cbranch_scc1 L_cs_137
    v_mov_b32 v60, 0x3f803f80
    v_mov_b32 v61, 0x3f803f80
    v_mov_b32 v62, 0x3f803f80
    v_mov_b32 v63, 0x3f803f80
    v_lshrrev_b32 v6, 4, v1
    v_lshlrev_b32 v6, 4, v6
    v_lshrrev_b32 v5, 4, v1
    v_bfe_u32 v44, v1, 2, 2
    v_lshl_add_u32 v5, v5, 3, v44
    v_mul_u32_u24 v5, 72, v5
    v_and_b32 v44, 3, v1
    v_lshl_add_u32 v5, v44, 3, v5
    v_add_u32 v5, 100832, v5
    ds_read_b64_tr_b16 v[16:17], v5 offset:0
    ds_read_b64_tr_b16 v[18:19], v5 offset:288
    ds_read_b64_tr_b16 v[20:21], v5 offset:2304
    ds_read_b64_tr_b16 v[22:23], v5 offset:2592
    ds_read_b64_tr_b16 v[24:25], v5 offset:4608
    ds_read_b64_tr_b16 v[26:27], v5 offset:4896
    ds_read_b64_tr_b16 v[28:29], v5 offset:6912
    ds_read_b64_tr_b16 v[30:31], v5 offset:7200
    ds_read_b64_tr_b16 v[32:33], v5 offset:9216
    ds_read_b64_tr_b16 v[34:35], v5 offset:9504
    ds_read_b64_tr_b16 v[36:37], v5 offset:11520
    ds_read_b64_tr_b16 v[38:39], v5 offset:11808
    ds_read_b64_tr_b16 v[40:41], v5 offset:13824
    ds_read_b64_tr_b16 v[42:43], v5 offset:14112
    s_waitcnt lgkmcnt(12)
    v_mfma_f32_16x16x32_bf16 v[12:15], v[16:19], v[60:63], 0
    ds_read_b64_tr_b16 v[16:17], v5 offset:16128
    ds_read_b64_tr_b16 v[18:19], v5 offset:16416
    s_waitcnt lgkmcnt(12)
    v_mfma_f32_16x16x32_bf16 v[12:15], v[20:23], v[60:63], v[12:15]
    ds_read_b64_tr_b16 v[20:21], v5 offset:18432
    ds_read_b64_tr_b16 v[22:23], v5 offset:18720
    s_waitcnt lgkmcnt(12)
    v_mfma_f32_16x16x32_bf16 v[12:15], v[24:27], v[60:63], v[12:15]
    ds_read_b64_tr_b16 v[24:25], v5 offset:20736
    ds_read_b64_tr_b16 v[26:27], v5 offset:21024
    s_waitcnt lgkmcnt(12)
    v_mfma_f32_16x16x32_bf16 v[12:15], v[28:31], v[60:63], v[12:15]
    ds_read_b64_tr_b16 v[28:29], v5 offset:23040
    ds_read_b64_tr_b16 v[30:31], v5 offset:23328
    s_waitcnt lgkmcnt(12)
    v_mfma_f32_16x16x32_bf16 v[12:15], v[32:35], v[60:63], v[12:15]
    ds_read_b64_tr_b16 v[32:33], v5 offset:25344
    ds_read_b64_tr_b16 v[34:35], v5 offset:25632
    s_waitcnt lgkmcnt(12)
    v_mfma_f32_16x16x32_bf16 v[12:15], v[36:39], v[60:63], v[12:15]
    ds_read_b64_tr_b16 v[36:37], v5 offset:27648
    ds_read_b64_tr_b16 v[38:39], v5 offset:27936
    s_waitcnt lgkmcnt(12)
    v_mfma_f32_16x16x32_bf16 v[12:15], v[40:43], v[60:63], v[12:15]
    ds_read_b64_tr_b16 v[40:41], v5 offset:29952
    ds_read_b64_tr_b16 v[42:43], v5 offset:30240
    s_waitcnt lgkmcnt(12)
    v_mfma_f32_16x16x32_bf16 v[12:15], v[16:19], v[60:63], v[12:15]
    ds_read_b64_tr_b16 v[16:17], v5 offset:32256
    ds_read_b64_tr_b16 v[18:19], v5 offset:32544
    s_waitcnt lgkmcnt(12)
    v_mfma_f32_16x16x32_bf16 v[12:15], v[20:23], v[60:63], v[12:15]
    ds_read_b64_tr_b16 v[20:21], v5 offset:34560
    ds_read_b64_tr_b16 v[22:23], v5 offset:34848
    s_waitcnt lgkmcnt(12)
    v_mfma_f32_16x16x32_bf16 v[12:15], v[24:27], v[60:63], v[12:15]
    ds_read_b64_tr_b16 v[24:25], v5 offset:36864
    ds_read_b64_tr_b16 v[26:27], v5 offset:37152
    s_waitcnt lgkmcnt(12)
    v_mfma_f32_16x16x32_bf16 v[12:15], v[28:31], v[60:63], v[12:15]
    ds_read_b64_tr_b16 v[28:29], v5 offset:39168
    ds_read_b64_tr_b16 v[30:31], v5 offset:39456
    s_waitcnt lgkmcnt(12)
    v_mfma_f32_16x16x32_bf16 v[12:15], v[32:35], v[60:63], v[12:15]
    s_waitcnt lgkmcnt(10)
    v_mfma_f32_16x16x32_bf16 v[12:15], v[36:39], v[60:63], v[12:15]
    s_waitcnt lgkmcnt(8)
    v_mfma_f32_16x16x32_bf16 v[12:15], v[40:43], v[60:63], v[12:15]
    s_waitcnt lgkmcnt(6)
    v_mfma_f32_16x16x32_bf16 v[12:15], v[16:19], v[60:63], v[12:15]
    s_waitcnt lgkmcnt(4)
    v_mfma_f32_16x16x32_bf16 v[12:15], v[20:23], v[60:63], v[12:15]
    s_waitcnt lgkmcnt(2)
    v_mfma_f32_16x16x32_bf16 v[12:15], v[24:27], v[60:63], v[12:15]
    s_waitcnt lgkmcnt(0)
    v_mfma_f32_16x16x32_bf16 v[12:15], v[28:31], v[60:63], v[12:15]
    s_nop 7
    ds_write_b128 v6, v[12:15] offset:6368
    s_nop 1
    ds_read_b64_tr_b16 v[16:17], v5 offset:32
    ds_read_b64_tr_b16 v[18:19], v5 offset:320
    ds_read_b64_tr_b16 v[20:21], v5 offset:2336
    ds_read_b64_tr_b16 v[22:23], v5 offset:2624
    ds_read_b64_tr_b16 v[24:25], v5 offset:4640
    ds_read_b64_tr_b16 v[26:27], v5 offset:4928
    ds_read_b64_tr_b16 v[28:29], v5 offset:6944
    ds_read_b64_tr_b16 v[30:31], v5 offset:7232
    ds_read_b64_tr_b16 v[32:33], v5 offset:9248
    ds_read_b64_tr_b16 v[34:35], v5 offset:9536
    ds_read_b64_tr_b16 v[36:37], v5 offset:11552
    ds_read_b64_tr_b16 v[38:39], v5 offset:11840
    ds_read_b64_tr_b16 v[40:41], v5 offset:13856
    ds_read_b64_tr_b16 v[42:43], v5 offset:14144
    s_waitcnt lgkmcnt(12)
    v_mfma_f32_16x16x32_bf16 v[12:15], v[16:19], v[60:63], 0
    ds_read_b64_tr_b16 v[16:17], v5 offset:16160
    ds_read_b64_tr_b16 v[18:19], v5 offset:16448
    s_waitcnt lgkmcnt(12)
    v_mfma_f32_16x16x32_bf16 v[12:15], v[20:23], v[60:63], v[12:15]
    ds_read_b64_tr_b16 v[20:21], v5 offset:18464
    ds_read_b64_tr_b16 v[22:23], v5 offset:18752
    s_waitcnt lgkmcnt(12)
    v_mfma_f32_16x16x32_bf16 v[12:15], v[24:27], v[60:63], v[12:15]
    ds_read_b64_tr_b16 v[24:25], v5 offset:20768
    ds_read_b64_tr_b16 v[26:27], v5 offset:21056
    s_waitcnt lgkmcnt(12)
    v_mfma_f32_16x16x32_bf16 v[12:15], v[28:31], v[60:63], v[12:15]
    ds_read_b64_tr_b16 v[28:29], v5 offset:23072
    ds_read_b64_tr_b16 v[30:31], v5 offset:23360
    s_waitcnt lgkmcnt(12)
    v_mfma_f32_16x16x32_bf16 v[12:15], v[32:35], v[60:63], v[12:15]
    ds_read_b64_tr_b16 v[32:33], v5 offset:25376
    ds_read_b64_tr_b16 v[34:35], v5 offset:25664
    s_waitcnt lgkmcnt(12)
    v_mfma_f32_16x16x32_bf16 v[12:15], v[36:39], v[60:63], v[12:15]
    ds_read_b64_tr_b16 v[36:37], v5 offset:27680
    ds_read_b64_tr_b16 v[38:39], v5 offset:27968
    s_waitcnt lgkmcnt(12)
    v_mfma_f32_16x16x32_bf16 v[12:15], v[40:43], v[60:63], v[12:15]
    ds_read_b64_tr_b16 v[40:41], v5 offset:29984
    ds_read_b64_tr_b16 v[42:43], v5 offset:30272
    s_waitcnt lgkmcnt(12)
    v_mfma_f32_16x16x32_bf16 v[12:15], v[16:19], v[60:63], v[12:15]
    ds_read_b64_tr_b16 v[16:17], v5 offset:32288
    ds_read_b64_tr_b16 v[18:19], v5 offset:32576
    s_waitcnt lgkmcnt(12)
    v_mfma_f32_16x16x32_bf16 v[12:15], v[20:23], v[60:63], v[12:15]
    ds_read_b64_tr_b16 v[20:21], v5 offset:34592
    ds_read_b64_tr_b16 v[22:23], v5 offset:34880
    s_waitcnt lgkmcnt(12)
    v_mfma_f32_16x16x32_bf16 v[12:15], v[24:27], v[60:63], v[12:15]
    ds_read_b64_tr_b16 v[24:25], v5 offset:36896
    ds_read_b64_tr_b16 v[26:27], v5 offset:37184
    s_waitcnt lgkmcnt(12)
    v_mfma_f32_16x16x32_bf16 v[12:15], v[28:31], v[60:63], v[12:15]
    ds_read_b64_tr_b16 v[28:29], v5 offset:39200
    ds_read_b64_tr_b16 v[30:31], v5 offset:39488
    s_waitcnt lgkmcnt(12)
    v_mfma_f32_16x16x32_bf16 v[12:15], v[32:35], v[60:63], v[12:15]
    s_waitcnt lgkmcnt(10)
    v_mfma_f32_16x16x32_bf16 v[12:15], v[36:39], v[60:63], v[12:15]
    s_waitcnt lgkmcnt(8)
    v_mfma_f32_16x16x32_bf16 v[12:15], v[40:43], v[60:63], v[12:15]
    s_waitcnt lgkmcnt(6)
    v_mfma_f32_16x16x32_bf16 v[12:15], v[16:19], v[60:63], v[12:15]
    s_waitcnt lgkmcnt(4)
    v_mfma_f32_16x16x32_bf16 v[12:15], v[20:23], v[60:63], v[12:15]
    s_waitcnt lgkmcnt(2)
    v_mfma_f32_16x16x32_bf16 v[12:15], v[24:27], v[60:63], v[12:15]
    s_waitcnt lgkmcnt(0)
    v_mfma_f32_16x16x32_bf16 v[12:15], v[28:31], v[60:63], v[12:15]
    s_nop 7
    ds_write_b128 v6, v[12:15] offset:6432
    s_nop 1
    ds_read_b64_tr_b16 v[16:17], v5 offset:64
    ds_read_b64_tr_b16 v[18:19], v5 offset:352
    ds_read_b64_tr_b16 v[20:21], v5 offset:2368
    ds_read_b64_tr_b16 v[22:23], v5 offset:2656
    ds_read_b64_tr_b16 v[24:25], v5 offset:4672
    ds_read_b64_tr_b16 v[26:27], v5 offset:4960
    ds_read_b64_tr_b16 v[28:29], v5 offset:6976
    ds_read_b64_tr_b16 v[30:31], v5 offset:7264
    ds_read_b64_tr_b16 v[32:33], v5 offset:9280
    ds_read_b64_tr_b16 v[34:35], v5 offset:9568
    ds_read_b64_tr_b16 v[36:37], v5 offset:11584
    ds_read_b64_tr_b16 v[38:39], v5 offset:11872
    ds_read_b64_tr_b16 v[40:41], v5 offset:13888
    ds_read_b64_tr_b16 v[42:43], v5 offset:14176
    s_waitcnt lgkmcnt(12)
    v_mfma_f32_16x16x32_bf16 v[12:15], v[16:19], v[60:63], 0
    ds_read_b64_tr_b16 v[16:17], v5 offset:16192
    ds_read_b64_tr_b16 v[18:19], v5 offset:16480
    s_waitcnt lgkmcnt(12)
    v_mfma_f32_16x16x32_bf16 v[12:15], v[20:23], v[60:63], v[12:15]
    ds_read_b64_tr_b16 v[20:21], v5 offset:18496
    ds_read_b64_tr_b16 v[22:23], v5 offset:18784
    s_waitcnt lgkmcnt(12)
    v_mfma_f32_16x16x32_bf16 v[12:15], v[24:27], v[60:63], v[12:15]
    ds_read_b64_tr_b16 v[24:25], v5 offset:20800
    ds_read_b64_tr_b16 v[26:27], v5 offset:21088
    s_waitcnt lgkmcnt(12)
    v_mfma_f32_16x16x32_bf16 v[12:15], v[28:31], v[60:63], v[12:15]
    ds_read_b64_tr_b16 v[28:29], v5 offset:23104
    ds_read_b64_tr_b16 v[30:31], v5 offset:23392
    s_waitcnt lgkmcnt(12)
    v_mfma_f32_16x16x32_bf16 v[12:15], v[32:35], v[60:63], v[12:15]
    ds_read_b64_tr_b16 v[32:33], v5 offset:25408
    ds_read_b64_tr_b16 v[34:35], v5 offset:25696
    s_waitcnt lgkmcnt(12)
    v_mfma_f32_16x16x32_bf16 v[12:15], v[36:39], v[60:63], v[12:15]
    ds_read_b64_tr_b16 v[36:37], v5 offset:27712
    ds_read_b64_tr_b16 v[38:39], v5 offset:28000
    s_waitcnt lgkmcnt(12)
    v_mfma_f32_16x16x32_bf16 v[12:15], v[40:43], v[60:63], v[12:15]
    ds_read_b64_tr_b16 v[40:41], v5 offset:30016
    ds_read_b64_tr_b16 v[42:43], v5 offset:30304
    s_waitcnt lgkmcnt(12)
    v_mfma_f32_16x16x32_bf16 v[12:15], v[16:19], v[60:63], v[12:15]
    ds_read_b64_tr_b16 v[16:17], v5 offset:32320
    ds_read_b64_tr_b16 v[18:19], v5 offset:32608
    s_waitcnt lgkmcnt(12)
    v_mfma_f32_16x16x32_bf16 v[12:15], v[20:23], v[60:63], v[12:15]
    ds_read_b64_tr_b16 v[20:21], v5 offset:34624
    ds_read_b64_tr_b16 v[22:23], v5 offset:34912
    s_waitcnt lgkmcnt(12)
    v_mfma_f32_16x16x32_bf16 v[12:15], v[24:27], v[60:63], v[12:15]
    ds_read_b64_tr_b16 v[24:25], v5 offset:36928
    ds_read_b64_tr_b16 v[26:27], v5 offset:37216
    s_waitcnt lgkmcnt(12)
    v_mfma_f32_16x16x32_bf16 v[12:15], v[28:31], v[60:63], v[12:15]
    ds_read_b64_tr_b16 v[28:29], v5 offset:39232
    ds_read_b64_tr_b16 v[30:31], v5 offset:39520
    s_waitcnt lgkmcnt(12)
    v_mfma_f32_16x16x32_bf16 v[12:15], v[32:35], v[60:63], v[12:15]
    s_waitcnt lgkmcnt(10)
    v_mfma_f32_16x16x32_bf16 v[12:15], v[36:39], v[60:63], v[12:15]
    s_waitcnt lgkmcnt(8)
    v_mfma_f32_16x16x32_bf16 v[12:15], v[40:43], v[60:63], v[12:15]
    s_waitcnt lgkmcnt(6)
    v_mfma_f32_16x16x32_bf16 v[12:15], v[16:19], v[60:63], v[12:15]
    s_waitcnt lgkmcnt(4)
    v_mfma_f32_16x16x32_bf16 v[12:15], v[20:23], v[60:63], v[12:15]
    s_waitcnt lgkmcnt(2)
    v_mfma_f32_16x16x32_bf16 v[12:15], v[24:27], v[60:63], v[12:15]
    s_waitcnt lgkmcnt(0)
    v_mfma_f32_16x16x32_bf16 v[12:15], v[28:31], v[60:63], v[12:15]
    s_nop 7
    ds_write_b128 v6, v[12:15] offset:6496
    s_nop 1
    v_lshrrev_b32 v5, 4, v1
    v_bfe_u32 v44, v1, 2, 2
    v_lshl_add_u32 v5, v5, 3, v44
    v_mul_u32_u24 v5, 32, v5
    v_and_b32 v44, 3, v1
    v_lshl_add_u32 v5, v44, 3, v5
    v_add_u32 v5, 6624, v5
    ds_read_b64_tr_b16 v[16:17], v5 offset:0
    ds_read_b64_tr_b16 v[18:19], v5 offset:128
    ds_read_b64_tr_b16 v[20:21], v5 offset:1024
    ds_read_b64_tr_b16 v[22:23], v5 offset:1152
    ds_read_b64_tr_b16 v[24:25], v5 offset:2048
    ds_read_b64_tr_b16 v[26:27], v5 offset:2176
    ds_read_b64_tr_b16 v[28:29], v5 offset:3072
    ds_read_b64_tr_b16 v[30:31], v5 offset:3200
    ds_read_b64_tr_b16 v[32:33], v5 offset:4096
    ds_read_b64_tr_b16 v[34:35], v5 offset:4224
    ds_read_b64_tr_b16 v[36:37], v5 offset:5120
    ds_read_b64_tr_b16 v[38:39], v5 offset:5248
    ds_read_b64_tr_b16 v[40:41], v5 offset:6144
    ds_read_b64_tr_b16 v[42:43], v5 offset:6272
    s_waitcnt lgkmcnt(12)
    v_mfma_f32_16x16x32_bf16 v[12:15], v[16:19], v[60:63], 0
    ds_read_b64_tr_b16 v[16:17], v5 offset:7168
    ds_read_b64_tr_b16 v[18:19], v5 offset:7296
    s_waitcnt lgkmcnt(12)
    v_mfma_f32_16x16x32_bf16 v[12:15], v[20:23], v[60:63], v[12:15]
    ds_read_b64_tr_b16 v[20:21], v5 offset:8192
    ds_read_b64_tr_b16 v[22:23], v5 offset:8320
    s_waitcnt lgkmcnt(12)
    v_mfma_f32_16x16x32_bf16 v[12:15], v[24:27], v[60:63], v[12:15]
    ds_read_b64_tr_b16 v[24:25], v5 offset:9216
    ds_read_b64_tr_b16 v[26:27], v5 offset:9344
    s_waitcnt lgkmcnt(12)
    v_mfma_f32_16x16x32_bf16 v[12:15], v[28:31], v[60:63], v[12:15]
    ds_read_b64_tr_b16 v[28:29], v5 offset:10240
    ds_read_b64_tr_b16 v[30:31], v5 offset:10368
    s_waitcnt lgkmcnt(12)
    v_mfma_f32_16x16x32_bf16 v[12:15], v[32:35], v[60:63], v[12:15]
    ds_read_b64_tr_b16 v[32:33], v5 offset:11264
    ds_read_b64_tr_b16 v[34:35], v5 offset:11392
    s_waitcnt lgkmcnt(12)
    v_mfma_f32_16x16x32_bf16 v[12:15], v[36:39], v[60:63], v[12:15]
    ds_read_b64_tr_b16 v[36:37], v5 offset:12288
    ds_read_b64_tr_b16 v[38:39], v5 offset:12416
    s_waitcnt lgkmcnt(12)
    v_mfma_f32_16x16x32_bf16 v[12:15], v[40:43], v[60:63], v[12:15]
    ds_read_b64_tr_b16 v[40:41], v5 offset:13312
    ds_read_b64_tr_b16 v[42:43], v5 offset:13440
    s_waitcnt lgkmcnt(12)
    v_mfma_f32_16x16x32_bf16 v[12:15], v[16:19], v[60:63], v[12:15]
    ds_read_b64_tr_b16 v[16:17], v5 offset:14336
    ds_read_b64_tr_b16 v[18:19], v5 offset:14464
    s_waitcnt lgkmcnt(12)
    v_mfma_f32_16x16x32_bf16 v[12:15], v[20:23], v[60:63], v[12:15]
    ds_read_b64_tr_b16 v[20:21], v5 offset:15360
    ds_read_b64_tr_b16 v[22:23], v5 offset:15488
    s_waitcnt lgkmcnt(12)
    v_mfma_f32_16x16x32_bf16 v[12:15], v[24:27], v[60:63], v[12:15]
    ds_read_b64_tr_b16 v[24:25], v5 offset:16384
    ds_read_b64_tr_b16 v[26:27], v5 offset:16512
    s_waitcnt lgkmcnt(12)
    v_mfma_f32_16x16x32_bf16 v[12:15], v[28:31], v[60:63], v[12:15]
    ds_read_b64_tr_b16 v[28:29], v5 offset:17408
    ds_read_b64_tr_b16 v[30:31], v5 offset:17536
    s_waitcnt lgkmcnt(12)
    v_mfma_f32_16x16x32_bf16 v[12:15], v[32:35], v[60:63], v[12:15]
    s_waitcnt lgkmcnt(10)
    v_mfma_f32_16x16x32_bf16 v[12:15], v[36:39], v[60:63], v[12:15]
    s_waitcnt lgkmcnt(8)
    v_mfma_f32_16x16x32_bf16 v[12:15], v[40:43], v[60:63], v[12:15]
    s_waitcnt lgkmcnt(6)
    v_mfma_f32_16x16x32_bf16 v[12:15], v[16:19], v[60:63], v[12:15]
    s_waitcnt lgkmcnt(4)
    v_mfma_f32_16x16x32_bf16 v[12:15], v[20:23], v[60:63], v[12:15]
    s_waitcnt lgkmcnt(2)
    v_mfma_f32_16x16x32_bf16 v[12:15], v[24:27], v[60:63], v[12:15]
    s_waitcnt lgkmcnt(0)
    v_mfma_f32_16x16x32_bf16 v[12:15], v[28:31], v[60:63], v[12:15]
    s_nop 7
    ds_write_b128 v6, v[12:15] offset:6560
    s_nop 1
L_cs_137:
    v_lshlrev_b32 v30, 1, v1
    v_mov_b32 v31, 6336
    s_waitcnt lgkmcnt(0)
    s_barrier
    ds_read_u16 v32, v30 offset:4160
    ds_read_u16 v33, v30 offset:4288
    ds_read_u16 v34, v30 offset:4416
    ds_read_u16 v35, v30 offset:4544
    ds_read_u16 v36, v30 offset:4672
    ds_read_u16 v37, v30 offset:4800
    ds_read_u16 v38, v30 offset:4928
    ds_read_u16 v39, v30 offset:5056
    ds_read_u16 v40, v30 offset:5184
    s_waitcnt lgkmcnt(8)
    v_lshlrev_b32 v32, 16, v32
    s_waitcnt lgkmcnt(7)
    v_lshlrev_b32 v33, 16, v33
    s_waitcnt lgkmcnt(6)
    v_lshlrev_b32 v34, 16, v34
    s_waitcnt lgkmcnt(5)
    v_lshlrev_b32 v35, 16, v35
    s_waitcnt lgkmcnt(4)
    v_lshlrev_b32 v36, 16, v36
    s_waitcnt lgkmcnt(3)
    v_lshlrev_b32 v37, 16, v37
    s_waitcnt lgkmcnt(2)
    v_lshlrev_b32 v38, 16, v38
    s_waitcnt lgkmcnt(1)
    v_lshlrev_b32 v39, 16, v39
    s_waitcnt lgkmcnt(0)
    v_lshlrev_b32 v40, 16, v40
    v_readfirstlane_b32 s52, v32
    s_nop 1
    v_subrev_f32 v20, s52, v32
    v_subrev_f32 v21, s52, v33
    v_subrev_f32 v22, s52, v34
    v_subrev_f32 v23, s52, v35
    v_subrev_f32 v24, s52, v36
    v_subrev_f32 v25, s52, v37
    v_subrev_f32 v26, s52, v38
    v_subrev_f32 v27, s52, v39
    v_subrev_f32 v28, s52, v40
    v_add_f32 v15, v20, v21
    v_mul_f32 v16, v20, v20
    v_add_f32 v15, v15, v22
    v_add_f32 v15, v15, v23
    v_add_f32 v15, v15, v24
    v_add_f32 v15, v15, v25
    v_add_f32 v15, v15, v26
    v_add_f32 v15, v15, v27
    v_add_f32 v15, v15, v28
    v_fmac_f32 v16, v21, v21
    v_fmac_f32 v16, v22, v22
    v_fmac_f32 v16, v23, v23
    v_fmac_f32 v16, v24, v24
    v_fmac_f32 v16, v25, v25
    v_fmac_f32 v16, v26, v26
    v_fmac_f32 v16, v27, v27
    v_fmac_f32 v16, v28, v28
    s_nop 0
    s_nop 0
    v_add_f32_dpp v15, v15, v15 quad_perm:[1,0,3,2] row_mask:0xf bank_mask:0xf
    v_add_f32_dpp v16, v16, v16 quad_perm:[1,0,3,2] row_mask:0xf bank_mask:0xf
    s_nop 0
    v_add_f32_dpp v15, v15, v15 quad_perm:[2,3,0,1] row_mask:0xf bank_mask:0xf
    v_add_f32_dpp v16, v16, v16 quad_perm:[2,3,0,1] row_mask:0xf bank_mask:0xf
    s_nop 0
    v_add_f32_dpp v15, v15, v15 row_half_mirror row_mask:0xf bank_mask:0xf
    v_add_f32_dpp v16, v16, v16 row_half_mirror row_mask:0xf bank_mask:0xf
    s_nop 0
    v_add_f32_dpp v15, v15, v15 row_mirror row_mask:0xf bank_mask:0xf
    v_add_f32_dpp v16, v16, v16 row_mirror row_mask:0xf bank_mask:0xf
    v_mov_b32 v17, v15
    v_mov_b32 v14, v16
    s_nop 0
    v_permlane16_swap_b32 v15, v17
    v_permlane16_swap_b32 v16, v14
    v_add_f32 v15, v15, v17
    v_add_f32 v16, v16, v14
    v_mov_b32 v17, v15
    v_mov_b32 v14, v16
    s_nop 0
    v_permlane32_swap_b32 v15, v17
    v_permlane32_swap_b32 v16, v14
    v_add_f32 v15, v15, v17
    v_add_f32 v16, v16, v14
    v_mul_f32 v17, 0x3ae38e39, v15
    v_add_f32 v18, s52, v17
    v_fma_f32 v16, -v17, v15, v16
    v_mul_f32 v16, 0x3ae38e39, v16
    v_max_f32 v13, 0, v16
    v_cvt_pk_bf16_f32 v13, 0, v13
    v_add_f32 v13, 0x3727c5ac, v13
    v_cvt_pk_bf16_f32 v13, 0, v13
    v_sqrt_f32 v13, v13
    v_cvt_pk_bf16_f32 v18, 0, v18
    v_cvt_pk_bf16_f32 v13, 0, v13
    v_rcp_f32 v19, v13
    s_nop 0
    ds_write_b64 v31, v[18:19]
    s_waitcnt lgkmcnt(0)
    s_barrier
    s_cmp_eq_u32 s50, 1
    s_cbranch_scc1 L_done2
    v_lshlrev_b32 v30, 1, v1
    v_mov_b32 v31, 6336
    s_waitcnt lgkmcnt(0)
    s_barrier
    ds_read_u16 v32, v30 offset:4160
    ds_read_u16 v33, v30 offset:4288
    ds_read_u16 v34, v30 offset:4416
    ds_read_u16 v35, v30 offset:4544
    ds_read_u16 v36, v30 offset:4672
    ds_read_u16 v37, v30 offset:4800
    ds_read_u16 v38, v30 offset:4928
    ds_read_u16 v39, v30 offset:5056
    ds_read_u16 v40, v30 offset:5184
    s_waitcnt lgkmcnt(8)
    v_lshlrev_b32 v32, 16, v32
    s_waitcnt lgkmcnt(7)
    v_lshlrev_b32 v33, 16, v33
    s_waitcnt lgkmcnt(6)
    v_lshlrev_b32 v34, 16, v34
    s_waitcnt lgkmcnt(5)
    v_lshlrev_b32 v35, 16, v35
    s_waitcnt lgkmcnt(4)
    v_lshlrev_b32 v36, 16, v36
    s_waitcnt lgkmcnt(3)
    v_lshlrev_b32 v37, 16, v37
    s_waitcnt lgkmcnt(2)
    v_lshlrev_b32 v38, 16, v38
    s_waitcnt lgkmcnt(1)
    v_lshlrev_b32 v39, 16, v39
    s_waitcnt lgkmcnt(0)
    v_lshlrev_b32 v40, 16, v40
    v_readfirstlane_b32 s52, v32
    s_nop 1
    v_subrev_f32 v20, s52, v32
    v_subrev_f32 v21, s52, v33
    v_subrev_f32 v22, s52, v34
    v_subrev_f32 v23, s52, v35
    v_subrev_f32 v24, s52, v36
    v_subrev_f32 v25, s52, v37
    v_subrev_f32 v26, s52, v38
    v_subrev_f32 v27, s52, v39
    v_subrev_f32 v28, s52, v40
    v_add_f32 v15, v20, v21
    v_mul_f32 v16, v20, v20
    v_add_f32 v15, v15, v22
    v_add_f32 v15, v15, v23
    v_add_f32 v15, v15, v24
    v_add_f32 v15, v15, v25
    v_add_f32 v15, v15, v26
    v_add_f32 v15, v15, v27
    v_add_f32 v15, v15, v28
    v_fmac_f32 v16, v21, v21
    v_fmac_f32 v16, v22, v22
    v_fmac_f32 v16, v23, v23
    v_fmac_f32 v16, v24, v24
    v_fmac_f32 v16, v25, v25
    v_fmac_f32 v16, v26, v26
    v_fmac_f32 v16, v27, v27
    v_fmac_f32 v16, v28, v28
    s_nop 0
    s_nop 0
    v_add_f32_dpp v15, v15, v15 quad_perm:[1,0,3,2] row_mask:0xf bank_mask:0xf
    v_add_f32_dpp v16, v16, v16 quad_perm:[1,0,3,2] row_mask:0xf bank_mask:0xf
    s_nop 0
    v_add_f32_dpp v15, v15, v15 quad_perm:[2,3,0,1] row_mask:0xf bank_mask:0xf
    v_add_f32_dpp v16, v16, v16 quad_perm:[2,3,0,1] row_mask:0xf bank_mask:0xf
    s_nop 0
    v_add_f32_dpp v15, v15, v15 row_half_mirror row_mask:0xf bank_mask:0xf
    v_add_f32_dpp v16, v16, v16 row_half_mirror row_mask:0xf bank_mask:0xf
    s_nop 0
    v_add_f32_dpp v15, v15, v15 row_mirror row_mask:0xf bank_mask:0xf
    v_add_f32_dpp v16, v16, v16 row_mirror row_mask:0xf bank_mask:0xf
    v_mov_b32 v17, v15
    v_mov_b32 v14, v16
    s_nop 0
    v_permlane16_swap_b32 v15, v17
    v_permlane16_swap_b32 v16, v14
    v_add_f32 v15, v15, v17
    v_add_f32 v16, v16, v14
    v_mov_b32 v17, v15
    v_mov_b32 v14, v16
    s_nop 0
    v_permlane32_swap_b32 v15, v17
    v_permlane32_swap_b32 v16, v14
    v_add_f32 v15, v15, v17
    v_add_f32 v16, v16, v14
    v_mul_f32 v17, 0x3ae38e39, v15
    v_add_f32 v18, s52, v17
    v_fma_f32 v16, -v17, v15, v16
    v_mul_f32 v16, 0x3ae38e39, v16
    v_max_f32 v13, 0, v16
    v_cvt_pk_bf16_f32 v13, 0, v13
    v_add_f32 v13, 0x3727c5ac, v13
    v_cvt_pk_bf16_f32 v13, 0, v13
    v_sqrt_f32 v13, v13
    v_cvt_pk_bf16_f32 v18, 0, v18
    v_cvt_pk_bf16_f32 v13, 0, v13
    v_rcp_f32 v19, v13
    s_nop 0
    ds_write_b64 v31, v[18:19]
    s_waitcnt lgkmcnt(0)
    s_barrier
    s_branch L_b11
L_final:
    s_cmp_lg_u32 s48, 0
    s_cbranch_scc1 L_done2
    s_mul_i32 s52, s49, 72
    v_subrev_u32 v48, s52, v7
    v_cmp_gt_u32 vcc, 0x48, v48
    s_and_saveexec_b64 s[64:65], vcc
    s_cbranch_execz L_done3
    s_waitcnt vmcnt(0)
    s_mov_b32 s59, 0
L_h4f:
    s_mov_b32 s53, 393216
    buffer_load_dwordx3 v[16:18], v7, s[12:15], s53 offen sc1
    s_mov_b32 s53, 395520
    buffer_load_dwordx3 v[20:22], v7, s[12:15], s53 offen sc1
    s_mov_b32 s53, 397824
    buffer_load_dwordx3 v[24:26], v7, s[12:15], s53 offen sc1
    s_mov_b32 s53, 400128
    buffer_load_dwordx3 v[28:30], v7, s[12:15], s53 offen sc1
    s_mov_b32 s53, 402432
    buffer_load_dwordx3 v[32:34], v7, s[12:15], s53 offen sc1
    s_mov_b32 s53, 404736
    buffer_load_dwordx3 v[36:38], v7, s[12:15], s53 offen sc1
    s_mov_b32 s53, 407040
    buffer_load_dwordx3 v[40:42], v7, s[12:15], s53 offen sc1
    s_mov_b32 s53, 409344
    buffer_load_dwordx3 v[44:46], v7, s[12:15], s53 offen sc1
    s_waitcnt vmcnt(6)
    v_pk_add_f32 v[16:17], v[16:17], v[20:21]
    v_add_f32 v18, v18, v22
    s_waitcnt vmcnt(5)
    v_pk_add_f32 v[16:17], v[16:17], v[24:25]
    v_add_f32 v18, v18, v26
    s_waitcnt vmcnt(4)
    v_pk_add_f32 v[16:17], v[16:17], v[28:29]
    v_add_f32 v18, v18, v30
    s_waitcnt vmcnt(3)
    v_pk_add_f32 v[16:17], v[16:17], v[32:33]
    v_add_f32 v18, v18, v34
    s_waitcnt vmcnt(2)
    v_pk_add_f32 v[16:17], v[16:17], v[36:37]
    v_add_f32 v18, v18, v38
    s_waitcnt vmcnt(1)
    v_pk_add_f32 v[16:17], v[16:17], v[40:41]
    v_add_f32 v18, v18, v42
    s_waitcnt vmcnt(0)
    v_pk_add_f32 v[16:17], v[16:17], v[44:45]
    v_add_f32 v18, v18, v46
    v_add_f32 v19, v16, v17
    v_cvt_pk_bf16_f32 v20, 0, v16
    v_cvt_pk_bf16_f32 v21, 0, v17
    v_cvt_pk_bf16_f32 v22, 0, v18
    v_cmp_u_f32 vcc, v19, v18
    s_cbranch_vccz L_ok_138
    s_add_u32 s59, s59, 1
    s_cmp_lt_u32 s59, 65536
    s_cbranch_scc1 L_h4f
L_ok_138:
    v_add_f32 v8, v8, v20
    v_add_f32 v9, v9, v21
    v_add_f32 v10, v10, v22
    v_cvt_pk_bf16_f32 v8, 0, v8
    v_cvt_pk_bf16_f32 v9, 0, v9
    v_cvt_pk_bf16_f32 v10, 0, v10
    v_lshrrev_b32 v19, 1, v7
    buffer_store_short_d16_hi v8, v19, s[44:47], 0 offen offset:0
    buffer_store_short_d16_hi v9, v19, s[44:47], 0 offen offset:2
    buffer_store_short_d16_hi v10, v19, s[44:47], 0 offen offset:4
    s_mov_b64 exec, -1
L_done3:
    s_mov_b64 exec, -1
L_done2:
L_done:
    s_endpgm
L_resc_15:
    s_nop 0
    v_max_f32_dpp v24, v15, v15 row_ror:12 row_mask:0xf bank_mask:0xf
    s_nop 1
    v_max_f32_dpp v24, v24, v24 row_ror:8 row_mask:0xf bank_mask:0xf
    v_mov_b32 v25, v24
    s_nop 1
    v_permlane16_swap_b32 v24, v25
    s_nop 1
    v_max_f32 v24, v24, v25
    v_mov_b32 v25, v24
    s_nop 1
    v_permlane32_swap_b32 v24, v25
    s_nop 1
    v_max3_f32 v12, v24, v25, v12
    v_mul_f32 v24, s51, v12
    v_sub_f32 v25, v13, v24
    v_exp_f32 v25, v25
    v_mov_b32 v13, v24
    v_mul_f32 v14, v14, v25
    v_mul_f32 v16, v16, v25
    v_mul_f32 v17, v17, v25
    v_mul_f32 v18, v18, v25
    v_mul_f32 v19, v19, v25
    s_branch L_back_16
L_rb_17:
    buffer_load_dwordx4 v[208:211], v3, s[8:11], s62 offen offset:0 nt
    buffer_load_dwordx4 v[212:215], v3, s[8:11], s62 offen offset:1024 nt
    buffer_load_dwordx4 v[216:219], v3, s[8:11], s62 offen offset:2048 nt
    buffer_load_dwordx4 v[220:223], v3, s[8:11], s62 offen offset:3072 nt
    s_branch L_re_18
L_resc_19:
    s_nop 0
    v_max_f32_dpp v24, v15, v15 row_ror:12 row_mask:0xf bank_mask:0xf
    s_nop 1
    v_max_f32_dpp v24, v24, v24 row_ror:8 row_mask:0xf bank_mask:0xf
    v_mov_b32 v25, v24
    s_nop 1
    v_permlane16_swap_b32 v24, v25
    s_nop 1
    v_max_f32 v24, v24, v25
    v_mov_b32 v25, v24
    s_nop 1
    v_permlane32_swap_b32 v24, v25
    s_nop 1
    v_max3_f32 v12, v24, v25, v12
    v_mul_f32 v24, s51, v12
    v_sub_f32 v25, v13, v24
    v_exp_f32 v25, v25
    v_mov_b32 v13, v24
    v_mul_f32 v14, v14, v25
    v_mul_f32 v16, v16, v25
    v_mul_f32 v17, v17, v25
    v_mul_f32 v18, v18, v25
    v_mul_f32 v19, v19, v25
    s_branch L_back_20
L_rb_21:
    buffer_load_dwordx4 v[240:243], v3, s[8:11], s62 offen offset:0 nt
    buffer_load_dwordx4 v[244:247], v3, s[8:11], s62 offen offset:1024 nt
    buffer_load_dwordx4 v[248:251], v3, s[8:11], s62 offen offset:2048 nt
    buffer_load_dwordx4 v[252:255], v3, s[8:11], s62 offen offset:3072 nt
    s_branch L_re_22
L_resc_24:
    s_nop 0
    v_max_f32_dpp v24, v15, v15 row_ror:12 row_mask:0xf bank_mask:0xf
    s_nop 1
    v_max_f32_dpp v24, v24, v24 row_ror:8 row_mask:0xf bank_mask:0xf
    v_mov_b32 v25, v24
    s_nop 1
    v_permlane16_swap_b32 v24, v25
    s_nop 1
    v_max_f32 v24, v24, v25
    v_mov_b32 v25, v24
    s_nop 1
    v_permlane32_swap_b32 v24, v25
    s_nop 1
    v_max3_f32 v12, v24, v25, v12
    v_mul_f32 v24, s51, v12
    v_sub_f32 v25, v13, v24
    v_exp_f32 v25, v25
    v_mov_b32 v13, v24
    v_mul_f32 v14, v14, v25
    v_mul_f32 v16, v16, v25
    v_mul_f32 v17, v17, v25
    v_mul_f32 v18, v18, v25
    v_mul_f32 v19, v19, v25
    s_branch L_back_25
L_resc_26:
    s_nop 0
    v_max_f32_dpp v24, v15, v15 row_ror:12 row_mask:0xf bank_mask:0xf
    s_nop 1
    v_max_f32_dpp v24, v24, v24 row_ror:8 row_mask:0xf bank_mask:0xf
    v_mov_b32 v25, v24
    s_nop 1
    v_permlane16_swap_b32 v24, v25
    s_nop 1
    v_max_f32 v24, v24, v25
    v_mov_b32 v25, v24
    s_nop 1
    v_permlane32_swap_b32 v24, v25
    s_nop 1
    v_max3_f32 v12, v24, v25, v12
    v_mul_f32 v24, s51, v12
    v_sub_f32 v25, v13, v24
    v_exp_f32 v25, v25
    v_mov_b32 v13, v24
    v_mul_f32 v14, v14, v25
    v_mul_f32 v16, v16, v25
    v_mul_f32 v17, v17, v25
    v_mul_f32 v18, v18, v25
    v_mul_f32 v19, v19, v25
    s_branch L_back_27
L_resc_28:
    s_nop 0
    v_max_f32_dpp v24, v15, v15 row_ror:12 row_mask:0xf bank_mask:0xf
    s_nop 1
    v_max_f32_dpp v24, v24, v24 row_ror:8 row_mask:0xf bank_mask:0xf
    v_mov_b32 v25, v24
    s_nop 1
    v_permlane16_swap_b32 v24, v25
    s_nop 1
    v_max_f32 v24, v24, v25
    v_mov_b32 v25, v24
    s_nop 1
    v_permlane32_swap_b32 v24, v25
    s_nop 1
    v_max3_f32 v12, v24, v25, v12
    v_mul_f32 v24, s51, v12
    v_sub_f32 v25, v13, v24
    v_exp_f32 v25, v25
    v_mov_b32 v13, v24
    v_mul_f32 v14, v14, v25
    v_mul_f32 v16, v16, v25
    v_mul_f32 v17, v17, v25
    v_mul_f32 v18, v18, v25
    v_mul_f32 v19, v19, v25
    s_branch L_back_29
L_rb_32:
    buffer_load_dwordx4 v[192:195], v2, s[4:7], s62 offen offset:0 nt
    buffer_load_dwordx4 v[196:199], v2, s[4:7], s62 offen offset:1024 nt
    buffer_load_dwordx4 v[200:203], v2, s[4:7], s62 offen offset:2048 nt
    buffer_load_dwordx4 v[204:207], v2, s[4:7], s62 offen offset:3072 nt
    buffer_load_dwordx4 v[208:211], v3, s[8:11], s62 offen offset:0 nt
    buffer_load_dwordx4 v[212:215], v3, s[8:11], s62 offen offset:1024 nt
    buffer_load_dwordx4 v[216:219], v3, s[8:11], s62 offen offset:2048 nt
    buffer_load_dwordx4 v[220:223], v3, s[8:11], s62 offen offset:3072 nt
    s_branch L_re_33
L_erp_30:
    s_sub_u32 s75, s75, 1
    v_readlane_b32 s52, v0, s75
    s_nop 0
    s_mov_b32 s62, s52
    s_branch L_eis_31
L_resc_34:
    s_nop 0
    v_max_f32_dpp v24, v15, v15 row_ror:12 row_mask:0xf bank_mask:0xf
    s_nop 1
    v_max_f32_dpp v24, v24, v24 row_ror:8 row_mask:0xf bank_mask:0xf
    v_mov_b32 v25, v24
    s_nop 1
    v_permlane16_swap_b32 v24, v25
    s_nop 1
    v_max_f32 v24, v24, v25
    v_mov_b32 v25, v24
    s_nop 1
    v_permlane32_swap_b32 v24, v25
    s_nop 1
    v_max3_f32 v12, v24, v25, v12
    v_mul_f32 v24, s51, v12
    v_sub_f32 v25, v13, v24
    v_exp_f32 v25, v25
    v_mov_b32 v13, v24
    v_mul_f32 v14, v14, v25
    v_mul_f32 v16, v16, v25
    v_mul_f32 v17, v17, v25
    v_mul_f32 v18, v18, v25
    v_mul_f32 v19, v19, v25
    s_branch L_back_35
L_resc_36:
    s_nop 0
    v_max_f32_dpp v24, v15, v15 row_ror:12 row_mask:0xf bank_mask:0xf
    s_nop 1
    v_max_f32_dpp v24, v24, v24 row_ror:8 row_mask:0xf bank_mask:0xf
    v_mov_b32 v25, v24
    s_nop 1
    v_permlane16_swap_b32 v24, v25
    s_nop 1
    v_max_f32 v24, v24, v25
    v_mov_b32 v25, v24
    s_nop 1
    v_permlane32_swap_b32 v24, v25
    s_nop 1
    v_max3_f32 v12, v24, v25, v12
    v_mul_f32 v24, s51, v12
    v_sub_f32 v25, v13, v24
    v_exp_f32 v25, v25
    v_mov_b32 v13, v24
    v_mul_f32 v14, v14, v25
    v_mul_f32 v16, v16, v25
    v_mul_f32 v17, v17, v25
    v_mul_f32 v18, v18, v25
    v_mul_f32 v19, v19, v25
    s_branch L_back_37
L_resc_38:
    s_nop 0
    v_max_f32_dpp v24, v15, v15 row_ror:12 row_mask:0xf bank_mask:0xf
    s_nop 1
    v_max_f32_dpp v24, v24, v24 row_ror:8 row_mask:0xf bank_mask:0xf
    v_mov_b32 v25, v24
    s_nop 1
    v_permlane16_swap_b32 v24, v25
    s_nop 1
    v_max_f32 v24, v24, v25
    v_mov_b32 v25, v24
    s_nop 1
    v_permlane32_swap_b32 v24, v25
    s_nop 1
    v_max3_f32 v12, v24, v25, v12
    v_mul_f32 v24, s51, v12
    v_sub_f32 v25, v13, v24
    v_exp_f32 v25, v25
    v_mov_b32 v13, v24
    v_mul_f32 v14, v14, v25
    v_mul_f32 v16, v16, v25
    v_mul_f32 v17, v17, v25
    v_mul_f32 v18, v18, v25
    v_mul_f32 v19, v19, v25
    s_branch L_back_39
L_rb_42:
    buffer_load_dwordx4 v[224:227], v2, s[4:7], s62 offen offset:0 nt
    buffer_load_dwordx4 v[228:231], v2, s[4:7], s62 offen offset:1024 nt
    buffer_load_dwordx4 v[232:235], v2, s[4:7], s62 offen offset:2048 nt
    buffer_load_dwordx4 v[236:239], v2, s[4:7], s62 offen offset:3072 nt
    buffer_load_dwordx4 v[240:243], v3, s[8:11], s62 offen offset:0 nt
    buffer_load_dwordx4 v[244:247], v3, s[8:11], s62 offen offset:1024 nt
    buffer_load_dwordx4 v[248:251], v3, s[8:11], s62 offen offset:2048 nt
    buffer_load_dwordx4 v[252:255], v3, s[8:11], s62 offen offset:3072 nt
    s_branch L_re_43
L_erp_40:
    s_sub_u32 s75, s75, 1
    v_readlane_b32 s52, v0, s75
    s_nop 0
    s_mov_b32 s62, s52
    s_branch L_eis_41
L_resc_44:
    s_nop 0
    v_max_f32_dpp v24, v15, v15 row_ror:12 row_mask:0xf bank_mask:0xf
    s_nop 1
    v_max_f32_dpp v24, v24, v24 row_ror:8 row_mask:0xf bank_mask:0xf
    v_mov_b32 v25, v24
    s_nop 1
    v_permlane16_swap_b32 v24, v25
    s_nop 1
    v_max_f32 v24, v24, v25
    v_mov_b32 v25, v24
    s_nop 1
    v_permlane32_swap_b32 v24, v25
    s_nop 1
    v_max3_f32 v12, v24, v25, v12
    v_mul_f32 v24, s51, v12
    v_sub_f32 v25, v13, v24
    v_exp_f32 v25, v25
    v_mov_b32 v13, v24
    v_mul_f32 v14, v14, v25
    v_mul_f32 v16, v16, v25
    v_mul_f32 v17, v17, v25
    v_mul_f32 v18, v18, v25
    v_mul_f32 v19, v19, v25
    s_branch L_back_45
L_resc_46:
    s_nop 0
    v_max_f32_dpp v24, v15, v15 row_ror:12 row_mask:0xf bank_mask:0xf
    s_nop 1
    v_max_f32_dpp v24, v24, v24 row_ror:8 row_mask:0xf bank_mask:0xf
    v_mov_b32 v25, v24
    s_nop 1
    v_permlane16_swap_b32 v24, v25
    s_nop 1
    v_max_f32 v24, v24, v25
    v_mov_b32 v25, v24
    s_nop 1
    v_permlane32_swap_b32 v24, v25
    s_nop 1
    v_max3_f32 v12, v24, v25, v12
    v_mul_f32 v24, s51, v12
    v_sub_f32 v25, v13, v24
    v_exp_f32 v25, v25
    v_mov_b32 v13, v24
    v_mul_f32 v14, v14, v25
    v_mul_f32 v16, v16, v25
    v_mul_f32 v17, v17, v25
    v_mul_f32 v18, v18, v25
    v_mul_f32 v19, v19, v25
    s_branch L_back_47
L_rb_50:
    buffer_load_dwordx4 v[192:195], v2, s[4:7], s62 offen offset:0 nt
    buffer_load_dwordx4 v[196:199], v2, s[4:7], s62 offen offset:1024 nt
    buffer_load_dwordx4 v[200:203], v2, s[4:7], s62 offen offset:2048 nt
    buffer_load_dwordx4 v[204:207], v2, s[4:7], s62 offen offset:3072 nt
    buffer_load_dwordx4 v[208:211], v3, s[8:11], s62 offen offset:0 nt
    buffer_load_dwordx4 v[212:215], v3, s[8:11], s62 offen offset:1024 nt
    buffer_load_dwordx4 v[216:219], v3, s[8:11], s62 offen offset:2048 nt
    buffer_load_dwordx4 v[220:223], v3, s[8:11], s62 offen offset:3072 nt
    s_branch L_re_51
L_erp_48:
    s_sub_u32 s75, s75, 1
    v_readlane_b32 s52, v0, s75
    s_nop 0
    s_mov_b32 s62, s52
    s_branch L_eis_49
L_resc_52:
    s_nop 0
    v_max_f32_dpp v24, v15, v15 row_ror:12 row_mask:0xf bank_mask:0xf
    s_nop 1
    v_max_f32_dpp v24, v24, v24 row_ror:8 row_mask:0xf bank_mask:0xf
    v_mov_b32 v25, v24
    s_nop 1
    v_permlane16_swap_b32 v24, v25
    s_nop 1
    v_max_f32 v24, v24, v25
    v_mov_b32 v25, v24
    s_nop 1
    v_permlane32_swap_b32 v24, v25
    s_nop 1
    v_max3_f32 v12, v24, v25, v12
    v_mul_f32 v24, s51, v12
    v_sub_f32 v25, v13, v24
    v_exp_f32 v25, v25
    v_mov_b32 v13, v24
    v_mul_f32 v14, v14, v25
    v_mul_f32 v16, v16, v25
    v_mul_f32 v17, v17, v25
    v_mul_f32 v18, v18, v25
    v_mul_f32 v19, v19, v25
    s_branch L_back_53
L_resc_54:
    s_nop 0
    v_max_f32_dpp v24, v15, v15 row_ror:12 row_mask:0xf bank_mask:0xf
    s_nop 1
    v_max_f32_dpp v24, v24, v24 row_ror:8 row_mask:0xf bank_mask:0xf
    v_mov_b32 v25, v24
    s_nop 1
    v_permlane16_swap_b32 v24, v25
    s_nop 1
    v_max_f32 v24, v24, v25
    v_mov_b32 v25, v24
    s_nop 1
    v_permlane32_swap_b32 v24, v25
    s_nop 1
    v_max3_f32 v12, v24, v25, v12
    v_mul_f32 v24, s51, v12
    v_sub_f32 v25, v13, v24
    v_exp_f32 v25, v25
    v_mov_b32 v13, v24
    v_mul_f32 v14, v14, v25
    v_mul_f32 v16, v16, v25
    v_mul_f32 v17, v17, v25
    v_mul_f32 v18, v18, v25
    v_mul_f32 v19, v19, v25
    s_branch L_back_55
L_resc_56:
    s_nop 0
    v_max_f32_dpp v24, v15, v15 row_ror:12 row_mask:0xf bank_mask:0xf
    s_nop 1
    v_max_f32_dpp v24, v24, v24 row_ror:8 row_mask:0xf bank_mask:0xf
    v_mov_b32 v25, v24
    s_nop 1
    v_permlane16_swap_b32 v24, v25
    s_nop 1
    v_max_f32 v24, v24, v25
    v_mov_b32 v25, v24
    s_nop 1
    v_permlane32_swap_b32 v24, v25
    s_nop 1
    v_max3_f32 v12, v24, v25, v12
    v_mul_f32 v24, s51, v12
    v_sub_f32 v25, v13, v24
    v_exp_f32 v25, v25
    v_mov_b32 v13, v24
    v_mul_f32 v14, v14, v25
    v_mul_f32 v16, v16, v25
    v_mul_f32 v17, v17, v25
    v_mul_f32 v18, v18, v25
    v_mul_f32 v19, v19, v25
    s_branch L_back_57
L_rb_60:
    buffer_load_dwordx4 v[224:227], v2, s[4:7], s62 offen offset:0 nt
    buffer_load_dwordx4 v[228:231], v2, s[4:7], s62 offen offset:1024 nt
    buffer_load_dwordx4 v[232:235], v2, s[4:7], s62 offen offset:2048 nt
    buffer_load_dwordx4 v[236:239], v2, s[4:7], s62 offen offset:3072 nt
    buffer_load_dwordx4 v[240:243], v3, s[8:11], s62 offen offset:0 nt
    buffer_load_dwordx4 v[244:247], v3, s[8:11], s62 offen offset:1024 nt
    buffer_load_dwordx4 v[248:251], v3, s[8:11], s62 offen offset:2048 nt
    buffer_load_dwordx4 v[252:255], v3, s[8:11], s62 offen offset:3072 nt
    s_branch L_re_61
L_erp_58:
    s_sub_u32 s75, s75, 1
    v_readlane_b32 s52, v0, s75
    s_nop 0
    s_mov_b32 s62, s52
    s_branch L_eis_59
L_resc_62:
    s_nop 0
    v_max_f32_dpp v24, v15, v15 row_ror:12 row_mask:0xf bank_mask:0xf
    s_nop 1
    v_max_f32_dpp v24, v24, v24 row_ror:8 row_mask:0xf bank_mask:0xf
    v_mov_b32 v25, v24
    s_nop 1
    v_permlane16_swap_b32 v24, v25
    s_nop 1
    v_max_f32 v24, v24, v25
    v_mov_b32 v25, v24
    s_nop 1
    v_permlane32_swap_b32 v24, v25
    s_nop 1
    v_max3_f32 v12, v24, v25, v12
    v_mul_f32 v24, s51, v12
    v_sub_f32 v25, v13, v24
    v_exp_f32 v25, v25
    v_mov_b32 v13, v24
    v_mul_f32 v14, v14, v25
    v_mul_f32 v16, v16, v25
    v_mul_f32 v17, v17, v25
    v_mul_f32 v18, v18, v25
    v_mul_f32 v19, v19, v25
    s_branch L_back_63
L_resc_64:
    s_nop 0
    v_max_f32_dpp v24, v15, v15 row_ror:12 row_mask:0xf bank_mask:0xf
    s_nop 1
    v_max_f32_dpp v24, v24, v24 row_ror:8 row_mask:0xf bank_mask:0xf
    v_mov_b32 v25, v24
    s_nop 1
    v_permlane16_swap_b32 v24, v25
    s_nop 1
    v_max_f32 v24, v24, v25
    v_mov_b32 v25, v24
    s_nop 1
    v_permlane32_swap_b32 v24, v25
    s_nop 1
    v_max3_f32 v12, v24, v25, v12
    v_mul_f32 v24, s51, v12
    v_sub_f32 v25, v13, v24
    v_exp_f32 v25, v25
    v_mov_b32 v13, v24
    v_mul_f32 v14, v14, v25
    v_mul_f32 v16, v16, v25
    v_mul_f32 v17, v17, v25
    v_mul_f32 v18, v18, v25
    v_mul_f32 v19, v19, v25
    s_branch L_back_65
L_rb_68:
    buffer_load_dwordx4 v[192:195], v2, s[4:7], s62 offen offset:0 nt
    buffer_load_dwordx4 v[196:199], v2, s[4:7], s62 offen offset:1024 nt
    buffer_load_dwordx4 v[200:203], v2, s[4:7], s62 offen offset:2048 nt
    buffer_load_dwordx4 v[204:207], v2, s[4:7], s62 offen offset:3072 nt
    buffer_load_dwordx4 v[208:211], v3, s[8:11], s62 offen offset:0 nt
    buffer_load_dwordx4 v[212:215], v3, s[8:11], s62 offen offset:1024 nt
    buffer_load_dwordx4 v[216:219], v3, s[8:11], s62 offen offset:2048 nt
    buffer_load_dwordx4 v[220:223], v3, s[8:11], s62 offen offset:3072 nt
    s_branch L_re_69
L_erp_66:
    s_sub_u32 s75, s75, 1
    v_readlane_b32 s52, v0, s75
    s_nop 0
    s_mov_b32 s62, s52
    s_branch L_eis_67
L_resc_70:
    s_nop 0
    v_max_f32_dpp v24, v15, v15 row_ror:12 row_mask:0xf bank_mask:0xf
    s_nop 1
    v_max_f32_dpp v24, v24, v24 row_ror:8 row_mask:0xf bank_mask:0xf
    v_mov_b32 v25, v24
    s_nop 1
    v_permlane16_swap_b32 v24, v25
    s_nop 1
    v_max_f32 v24, v24, v25
    v_mov_b32 v25, v24
    s_nop 1
    v_permlane32_swap_b32 v24, v25
    s_nop 1
    v_max3_f32 v12, v24, v25, v12
    v_mul_f32 v24, s51, v12
    v_sub_f32 v25, v13, v24
    v_exp_f32 v25, v25
    v_mov_b32 v13, v24
    v_mul_f32 v14, v14, v25
    v_mul_f32 v16, v16, v25
    v_mul_f32 v17, v17, v25
    v_mul_f32 v18, v18, v25
    v_mul_f32 v19, v19, v25
    s_branch L_back_71
L_resc_72:
    s_nop 0
    v_max_f32_dpp v24, v15, v15 row_ror:12 row_mask:0xf bank_mask:0xf
    s_nop 1
    v_max_f32_dpp v24, v24, v24 row_ror:8 row_mask:0xf bank_mask:0xf
    v_mov_b32 v25, v24
    s_nop 1
    v_permlane16_swap_b32 v24, v25
    s_nop 1
    v_max_f32 v24, v24, v25
    v_mov_b32 v25, v24
    s_nop 1
    v_permlane32_swap_b32 v24, v25
    s_nop 1
    v_max3_f32 v12, v24, v25, v12
    v_mul_f32 v24, s51, v12
    v_sub_f32 v25, v13, v24
    v_exp_f32 v25, v25
    v_mov_b32 v13, v24
    v_mul_f32 v14, v14, v25
    v_mul_f32 v16, v16, v25
    v_mul_f32 v17, v17, v25
    v_mul_f32 v18, v18, v25
    v_mul_f32 v19, v19, v25
    s_branch L_back_73
L_resc_74:
    s_nop 0
    v_max_f32_dpp v24, v15, v15 row_ror:12 row_mask:0xf bank_mask:0xf
    s_nop 1
    v_max_f32_dpp v24, v24, v24 row_ror:8 row_mask:0xf bank_mask:0xf
    v_mov_b32 v25, v24
    s_nop 1
    v_permlane16_swap_b32 v24, v25
    s_nop 1
    v_max_f32 v24, v24, v25
    v_mov_b32 v25, v24
    s_nop 1
    v_permlane32_swap_b32 v24, v25
    s_nop 1
    v_max3_f32 v12, v24, v25, v12
    v_mul_f32 v24, s51, v12
    v_sub_f32 v25, v13, v24
    v_exp_f32 v25, v25
    v_mov_b32 v13, v24
    v_mul_f32 v14, v14, v25
    v_mul_f32 v16, v16, v25
    v_mul_f32 v17, v17, v25
    v_mul_f32 v18, v18, v25
    v_mul_f32 v19, v19, v25
    s_branch L_back_75
L_rb_78:
    buffer_load_dwordx4 v[224:227], v2, s[4:7], s62 offen offset:0 nt
    buffer_load_dwordx4 v[228:231], v2, s[4:7], s62 offen offset:1024 nt
    buffer_load_dwordx4 v[232:235], v2, s[4:7], s62 offen offset:2048 nt
    buffer_load_dwordx4 v[236:239], v2, s[4:7], s62 offen offset:3072 nt
    buffer_load_dwordx4 v[240:243], v3, s[8:11], s62 offen offset:0 nt
    buffer_load_dwordx4 v[244:247], v3, s[8:11], s62 offen offset:1024 nt
    buffer_load_dwordx4 v[248:251], v3, s[8:11], s62 offen offset:2048 nt
    buffer_load_dwordx4 v[252:255], v3, s[8:11], s62 offen offset:3072 nt
    s_branch L_re_79
L_erp_76:
    s_sub_u32 s75, s75, 1
    v_readlane_b32 s52, v0, s75
    s_nop 0
    s_mov_b32 s62, s52
    s_branch L_eis_77
L_resc_80:
    s_nop 0
    v_max_f32_dpp v24, v15, v15 row_ror:12 row_mask:0xf bank_mask:0xf
    s_nop 1
    v_max_f32_dpp v24, v24, v24 row_ror:8 row_mask:0xf bank_mask:0xf
    v_mov_b32 v25, v24
    s_nop 1
    v_permlane16_swap_b32 v24, v25
    s_nop 1
    v_max_f32 v24, v24, v25
    v_mov_b32 v25, v24
    s_nop 1
    v_permlane32_swap_b32 v24, v25
    s_nop 1
    v_max3_f32 v12, v24, v25, v12
    v_mul_f32 v24, s51, v12
    v_sub_f32 v25, v13, v24
    v_exp_f32 v25, v25
    v_mov_b32 v13, v24
    v_mul_f32 v14, v14, v25
    v_mul_f32 v16, v16, v25
    v_mul_f32 v17, v17, v25
    v_mul_f32 v18, v18, v25
    v_mul_f32 v19, v19, v25
    s_branch L_back_81
L_resc_82:
    s_nop 0
    v_max_f32_dpp v24, v15, v15 row_ror:12 row_mask:0xf bank_mask:0xf
    s_nop 1
    v_max_f32_dpp v24, v24, v24 row_ror:8 row_mask:0xf bank_mask:0xf
    v_mov_b32 v25, v24
    s_nop 1
    v_permlane16_swap_b32 v24, v25
    s_nop 1
    v_max_f32 v24, v24, v25
    v_mov_b32 v25, v24
    s_nop 1
    v_permlane32_swap_b32 v24, v25
    s_nop 1
    v_max3_f32 v12, v24, v25, v12
    v_mul_f32 v24, s51, v12
    v_sub_f32 v25, v13, v24
    v_exp_f32 v25, v25
    v_mov_b32 v13, v24
    v_mul_f32 v14, v14, v25
    v_mul_f32 v16, v16, v25
    v_mul_f32 v17, v17, v25
    v_mul_f32 v18, v18, v25
    v_mul_f32 v19, v19, v25
    s_branch L_back_83
L_rb_86:
    buffer_load_dwordx4 v[192:195], v2, s[4:7], s62 offen offset:0 nt
    buffer_load_dwordx4 v[196:199], v2, s[4:7], s62 offen offset:1024 nt
    buffer_load_dwordx4 v[200:203], v2, s[4:7], s62 offen offset:2048 nt
    buffer_load_dwordx4 v[204:207], v2, s[4:7], s62 offen offset:3072 nt
    buffer_load_dwordx4 v[208:211], v3, s[8:11], s62 offen offset:0 nt
    buffer_load_dwordx4 v[212:215], v3, s[8:11], s62 offen offset:1024 nt
    buffer_load_dwordx4 v[216:219], v3, s[8:11], s62 offen offset:2048 nt
    buffer_load_dwordx4 v[220:223], v3, s[8:11], s62 offen offset:3072 nt
    s_branch L_re_87
L_erp_84:
    s_sub_u32 s75, s75, 1
    v_readlane_b32 s52, v0, s75
    s_nop 0
    s_mov_b32 s62, s52
    s_branch L_eis_85
L_resc_88:
    s_nop 0
    v_max_f32_dpp v24, v15, v15 row_ror:12 row_mask:0xf bank_mask:0xf
    s_nop 1
    v_max_f32_dpp v24, v24, v24 row_ror:8 row_mask:0xf bank_mask:0xf
    v_mov_b32 v25, v24
    s_nop 1
    v_permlane16_swap_b32 v24, v25
    s_nop 1
    v_max_f32 v24, v24, v25
    v_mov_b32 v25, v24
    s_nop 1
    v_permlane32_swap_b32 v24, v25
    s_nop 1
    v_max3_f32 v12, v24, v25, v12
    v_mul_f32 v24, s51, v12
    v_sub_f32 v25, v13, v24
    v_exp_f32 v25, v25
    v_mov_b32 v13, v24
    v_mul_f32 v14, v14, v25
    v_mul_f32 v16, v16, v25
    v_mul_f32 v17, v17, v25
    v_mul_f32 v18, v18, v25
    v_mul_f32 v19, v19, v25
    s_branch L_back_89
L_resc_90:
    s_nop 0
    v_max_f32_dpp v24, v15, v15 row_ror:12 row_mask:0xf bank_mask:0xf
    s_nop 1
    v_max_f32_dpp v24, v24, v24 row_ror:8 row_mask:0xf bank_mask:0xf
    v_mov_b32 v25, v24
    s_nop 1
    v_permlane16_swap_b32 v24, v25
    s_nop 1
    v_max_f32 v24, v24, v25
    v_mov_b32 v25, v24
    s_nop 1
    v_permlane32_swap_b32 v24, v25
    s_nop 1
    v_max3_f32 v12, v24, v25, v12
    v_mul_f32 v24, s51, v12
    v_sub_f32 v25, v13, v24
    v_exp_f32 v25, v25
    v_mov_b32 v13, v24
    v_mul_f32 v14, v14, v25
    v_mul_f32 v16, v16, v25
    v_mul_f32 v17, v17, v25
    v_mul_f32 v18, v18, v25
    v_mul_f32 v19, v19, v25
    s_branch L_back_91
L_resc_92:
    s_nop 0
    v_max_f32_dpp v24, v15, v15 row_ror:12 row_mask:0xf bank_mask:0xf
    s_nop 1
    v_max_f32_dpp v24, v24, v24 row_ror:8 row_mask:0xf bank_mask:0xf
    v_mov_b32 v25, v24
    s_nop 1
    v_permlane16_swap_b32 v24, v25
    s_nop 1
    v_max_f32 v24, v24, v25
    v_mov_b32 v25, v24
    s_nop 1
    v_permlane32_swap_b32 v24, v25
    s_nop 1
    v_max3_f32 v12, v24, v25, v12
    v_mul_f32 v24, s51, v12
    v_sub_f32 v25, v13, v24
    v_exp_f32 v25, v25
    v_mov_b32 v13, v24
    v_mul_f32 v14, v14, v25
    v_mul_f32 v16, v16, v25
    v_mul_f32 v17, v17, v25
    v_mul_f32 v18, v18, v25
    v_mul_f32 v19, v19, v25
    s_branch L_back_93
L_rb_96:
    buffer_load_dwordx4 v[224:227], v2, s[4:7], s62 offen offset:0 nt
    buffer_load_dwordx4 v[228:231], v2, s[4:7], s62 offen offset:1024 nt
    buffer_load_dwordx4 v[232:235], v2, s[4:7], s62 offen offset:2048 nt
    buffer_load_dwordx4 v[236:239], v2, s[4:7], s62 offen offset:3072 nt
    buffer_load_dwordx4 v[240:243], v3, s[8:11], s62 offen offset:0 nt
    buffer_load_dwordx4 v[244:247], v3, s[8:11], s62 offen offset:1024 nt
    buffer_load_dwordx4 v[248:251], v3, s[8:11], s62 offen offset:2048 nt
    buffer_load_dwordx4 v[252:255], v3, s[8:11], s62 offen offset:3072 nt
    s_branch L_re_97
L_erp_94:
    s_sub_u32 s75, s75, 1
    v_readlane_b32 s52, v0, s75
    s_nop 0
    s_mov_b32 s62, s52
    s_branch L_eis_95
L_resc_98:
    s_nop 0
    v_max_f32_dpp v24, v15, v15 row_ror:12 row_mask:0xf bank_mask:0xf
    s_nop 1
    v_max_f32_dpp v24, v24, v24 row_ror:8 row_mask:0xf bank_mask:0xf
    v_mov_b32 v25, v24
    s_nop 1
    v_permlane16_swap_b32 v24, v25
    s_nop 1
    v_max_f32 v24, v24, v25
    v_mov_b32 v25, v24
    s_nop 1
    v_permlane32_swap_b32 v24, v25
    s_nop 1
    v_max3_f32 v12, v24, v25, v12
    v_mul_f32 v24, s51, v12
    v_sub_f32 v25, v13, v24
    v_exp_f32 v25, v25
    v_mov_b32 v13, v24
    v_mul_f32 v14, v14, v25
    v_mul_f32 v16, v16, v25
    v_mul_f32 v17, v17, v25
    v_mul_f32 v18, v18, v25
    v_mul_f32 v19, v19, v25
    s_branch L_back_99
L_resc_101:
    s_nop 0
    v_max_f32_dpp v24, v15, v15 row_ror:12 row_mask:0xf bank_mask:0xf
    s_nop 1
    v_max_f32_dpp v24, v24, v24 row_ror:8 row_mask:0xf bank_mask:0xf
    v_mov_b32 v25, v24
    s_nop 1
    v_permlane16_swap_b32 v24, v25
    s_nop 1
    v_max_f32 v24, v24, v25
    v_mov_b32 v25, v24
    s_nop 1
    v_permlane32_swap_b32 v24, v25
    s_nop 1
    v_max3_f32 v12, v24, v25, v12
    v_mul_f32 v24, s51, v12
    v_sub_f32 v25, v13, v24
    v_exp_f32 v25, v25
    v_mov_b32 v13, v24
    v_mul_f32 v14, v14, v25
    v_mul_f32 v16, v16, v25
    v_mul_f32 v17, v17, v25
    v_mul_f32 v18, v18, v25
    v_mul_f32 v19, v19, v25
    s_branch L_back_102
L_rb_110:
    s_cmp_lg_u32 s60, 0
    s_cbranch_scc1 L_rh_112
    s_waitcnt vmcnt(5)
    buffer_load_dwordx4 v[192:195], v2, s[4:7], s62 offen offset:0 nt
    s_waitcnt vmcnt(5)
    buffer_load_dwordx4 v[196:199], v2, s[4:7], s62 offen offset:1024 nt
    s_waitcnt vmcnt(5)
    buffer_load_dwordx4 v[200:203], v2, s[4:7], s62 offen offset:2048 nt
    s_waitcnt vmcnt(5)
    buffer_load_dwordx4 v[204:207], v2, s[4:7], s62 offen offset:3072 nt
    s_waitcnt vmcnt(5)
    buffer_load_dwordx4 v[208:211], v3, s[8:11], s62 offen offset:0 nt
    s_waitcnt vmcnt(5)
    buffer_load_dwordx4 v[212:215], v3, s[8:11], s62 offen offset:1024 nt
    s_waitcnt vmcnt(5)
    buffer_load_dwordx4 v[216:219], v3, s[8:11], s62 offen offset:2048 nt
    s_waitcnt vmcnt(5)
    buffer_load_dwordx4 v[220:223], v3, s[8:11], s62 offen offset:3072 nt
    s_branch L_re_111
L_rh_112:
    s_sub_u32 s60, s60, 1
    s_waitcnt vmcnt(10)
    buffer_load_dwordx4 v[192:195], v2, s[4:7], s62 offen offset:0 nt
    s_waitcnt vmcnt(10)
    buffer_load_dwordx4 v[196:199], v2, s[4:7], s62 offen offset:1024 nt
    s_waitcnt vmcnt(10)
    buffer_load_dwordx4 v[200:203], v2, s[4:7], s62 offen offset:2048 nt
    s_waitcnt vmcnt(10)
    buffer_load_dwordx4 v[204:207], v2, s[4:7], s62 offen offset:3072 nt
    s_waitcnt vmcnt(10)
    buffer_load_dwordx4 v[208:211], v3, s[8:11], s62 offen offset:0 nt
    s_waitcnt vmcnt(10)
    buffer_load_dwordx4 v[212:215], v3, s[8:11], s62 offen offset:1024 nt
    s_waitcnt vmcnt(10)
    buffer_load_dwordx4 v[216:219], v3, s[8:11], s62 offen offset:2048 nt
    s_waitcnt vmcnt(10)
    buffer_load_dwordx4 v[220:223], v3, s[8:11], s62 offen offset:3072 nt
    s_branch L_re_111
L_dyn_104:
    s_waitcnt lgkmcnt(0)
    s_cmp_ge_u32 s81, s65
    s_cbranch_scc1 L_fin_106
    s_bfe_u32 s53, s81, 0x40002
    s_lshl_b32 s62, s53, 20
    s_lshr_b32 s52, s81, 6
    s_lshl_b32 s52, s52, 14
    s_add_u32 s62, s62, s52
    s_and_b32 s52, s81, 3
    s_lshl_b32 s52, s52, 12
    s_add_u32 s62, s62, s52
    s_add_u32 s62, s62, s66
    s_add_u32 s52, s81, 48
    s_cmp_ge_u32 s52, s65
    s_cselect_b32 s60, 1, s60
    s_cmp_lg_u32 s50, 0
    s_cbranch_scc1 L_req_108
    s_mov_b32 m0, s101
    s_add_u32 s101, s101, 1
    v_writelane_b32 v0, s62, m0
    s_cmp_ge_u32 s101, 64
    s_cbranch_scc1 L_cap_113
L_req_108:
    s_mov_b32 s81, 1
    s_atomic_add s81, s[82:83], 0 glc
    s_branch L_iss_103
L_cap_113:
    s_mov_b32 s81, -1
    s_branch L_iss_103
L_rp_109:
    s_sub_u32 s75, s75, 1
    v_readlane_b32 s52, v0, s75
    s_nop 0
    s_mov_b32 s62, s52
    s_branch L_iss_103
L_fin_106:
    s_cmp_eq_u32 s57, 0
    s_cbranch_scc1 L_nof_107
    s_mov_b32 s67, 0
    s_cmp_le_u32 s57, 1
    s_cselect_b32 s60, 1, 0
    s_mov_b32 s62, s58
    s_add_u32 s58, s58, 16384
    s_sub_u32 s57, s57, 1
    s_branch L_iss_103
L_nof_107:
    s_sub_u32 s56, s56, 1
    s_cmp_eq_u32 s56, 0
    s_cbranch_scc1 L_pass_end
    s_branch L_nxt_105
L_resc_115:
    s_nop 0
    v_max_f32_dpp v24, v15, v15 row_ror:12 row_mask:0xf bank_mask:0xf
    s_nop 1
    v_max_f32_dpp v24, v24, v24 row_ror:8 row_mask:0xf bank_mask:0xf
    v_mov_b32 v25, v24
    s_nop 1
    v_permlane16_swap_b32 v24, v25
    s_nop 1
    v_max_f32 v24, v24, v25
    v_mov_b32 v25, v24
    s_nop 1
    v_permlane32_swap_b32 v24, v25
    s_nop 1
    v_max3_f32 v12, v24, v25, v12
    v_mul_f32 v24, s51, v12
    v_sub_f32 v25, v13, v24
    v_exp_f32 v25, v25
    v_mov_b32 v13, v24
    v_mul_f32 v14, v14, v25
    v_mul_f32 v16, v16, v25
    v_mul_f32 v17, v17, v25
    v_mul_f32 v18, v18, v25
    v_mul_f32 v19, v19, v25
    s_branch L_back_116
L_rb_124:
    s_cmp_lg_u32 s60, 0
    s_cbranch_scc1 L_rh_126
    s_waitcnt vmcnt(5)
    buffer_load_dwordx4 v[224:227], v2, s[4:7], s62 offen offset:0 nt
    s_waitcnt vmcnt(5)
    buffer_load_dwordx4 v[228:231], v2, s[4:7], s62 offen offset:1024 nt
    s_waitcnt vmcnt(5)
    buffer_load_dwordx4 v[232:235], v2, s[4:7], s62 offen offset:2048 nt
    s_waitcnt vmcnt(5)
    buffer_load_dwordx4 v[236:239], v2, s[4:7], s62 offen offset:3072 nt
    s_waitcnt vmcnt(5)
    buffer_load_dwordx4 v[240:243], v3, s[8:11], s62 offen offset:0 nt
    s_waitcnt vmcnt(5)
    buffer_load_dwordx4 v[244:247], v3, s[8:11], s62 offen offset:1024 nt
    s_waitcnt vmcnt(5)
    buffer_load_dwordx4 v[248:251], v3, s[8:11], s62 offen offset:2048 nt
    s_waitcnt vmcnt(5)
    buffer_load_dwordx4 v[252:255], v3, s[8:11], s62 offen offset:3072 nt
    s_branch L_re_125
L_rh_126:
    s_sub_u32 s60, s60, 1
    s_waitcnt vmcnt(10)
    buffer_load_dwordx4 v[224:227], v2, s[4:7], s62 offen offset:0 nt
    s_waitcnt vmcnt(10)
    buffer_load_dwordx4 v[228:231], v2, s[4:7], s62 offen offset:1024 nt
    s_waitcnt vmcnt(10)
    buffer_load_dwordx4 v[232:235], v2, s[4:7], s62 offen offset:2048 nt
    s_waitcnt vmcnt(10)
    buffer_load_dwordx4 v[236:239], v2, s[4:7], s62 offen offset:3072 nt
    s_waitcnt vmcnt(10)
    buffer_load_dwordx4 v[240:243], v3, s[8:11], s62 offen offset:0 nt
    s_waitcnt vmcnt(10)
    buffer_load_dwordx4 v[244:247], v3, s[8:11], s62 offen offset:1024 nt
    s_waitcnt vmcnt(10)
    buffer_load_dwordx4 v[248:251], v3, s[8:11], s62 offen offset:2048 nt
    s_waitcnt vmcnt(10)
    buffer_load_dwordx4 v[252:255], v3, s[8:11], s62 offen offset:3072 nt
    s_branch L_re_125
L_dyn_118:
    s_waitcnt lgkmcnt(0)
    s_cmp_ge_u32 s81, s65
    s_cbranch_scc1 L_fin_120
    s_bfe_u32 s53, s81, 0x40002
    s_lshl_b32 s62, s53, 20
    s_lshr_b32 s52, s81, 6
    s_lshl_b32 s52, s52, 14
    s_add_u32 s62, s62, s52
    s_and_b32 s52, s81, 3
    s_lshl_b32 s52, s52, 12
    s_add_u32 s62, s62, s52
    s_add_u32 s62, s62, s66
    s_add_u32 s52, s81, 48
    s_cmp_ge_u32 s52, s65
    s_cselect_b32 s60, 1, s60
    s_cmp_lg_u32 s50, 0
    s_cbranch_scc1 L_req_122
    s_mov_b32 m0, s101
    s_add_u32 s101, s101, 1
    v_writelane_b32 v0, s62, m0
    s_cmp_ge_u32 s101, 64
    s_cbranch_scc1 L_cap_127
L_req_122:
    s_mov_b32 s81, 1
    s_atomic_add s81, s[82:83], 0 glc
    s_branch L_iss_117
L_cap_127:
    s_mov_b32 s81, -1
    s_branch L_iss_117
L_rp_123:
    s_sub_u32 s75, s75, 1
    v_readlane_b32 s52, v0, s75
    s_nop 0
    s_mov_b32 s62, s52
    s_branch L_iss_117
L_fin_120:
    s_cmp_eq_u32 s57, 0
    s_cbranch_scc1 L_nof_121
    s_mov_b32 s67, 0
    s_cmp_le_u32 s57, 1
    s_cselect_b32 s60, 1, 0
    s_mov_b32 s62, s58
    s_add_u32 s58, s58, 16384
    s_sub_u32 s57, s57, 1
    s_branch L_iss_117
L_nof_121:
    s_sub_u32 s56, s56, 1
    s_cmp_eq_u32 s56, 0
    s_cbranch_scc1 L_pass_end
    s_branch L_nxt_119
.section .rodata,"a"
.p2align 6
.amdhsa_kernel interleave_layers__gqa_block_cached__glu_gated_reglu__decode_kernel
  .amdhsa_next_free_vgpr 512
  .amdhsa_next_free_sgpr 102
  .amdhsa_accum_offset 256
  .amdhsa_group_segment_fixed_size 0
  .amdhsa_kernarg_size 96
  .amdhsa_user_sgpr_count 2
  .amdhsa_user_sgpr_kernarg_segment_ptr 1
  .amdhsa_system_sgpr_workgroup_id_x 1
  .amdhsa_float_denorm_mode_32 3
.end_amdhsa_kernel
```
